```python
import torch

def _softmax(x, axis=-1):
    return torch.softmax(x, dim=axis)
def _gelu(x):
    return torch.nn.functional.gelu(x, approximate="tanh")
def _silu(x):
    return torch.nn.functional.silu(x)
def _sigmoid(x):
    return torch.sigmoid(x)
def _layernorm(x, axis=-1, eps=1e-5):
    m = x.mean(dim=axis, keepdim=True)
    v = x.var(dim=axis, keepdim=True, unbiased=False)
    return (x - m) / torch.sqrt(v + eps)
def _scatter_add(tgt, idx, src, axis=0):
    return tgt.clone().index_add_(axis, idx, src)
def _segment_sum(src, seg, n):
    out = torch.zeros((n,) + src.shape[1:], dtype=src.dtype)
    return out.index_add_(0, seg, src)
def _pad(x, pw):
    flat = tuple(v for pair in reversed(pw) for v in pair)
    return torch.nn.functional.pad(x, flat)

kernel_name = 'standalone__dense_activation_silu__sampling'

def setup_inputs():

    _w = (lambda a: (lambda t: t.to(torch.bfloat16) if t.is_floating_point() else t)(torch.as_tensor(a)))
    B, S, D, F = 16, 32, 576, 4608
    return {
        "x": _w((lambda *s: torch.randn(*s, dtype=torch.bfloat16) * 0.1)(B, S, D)),
        "w1": _w((lambda *s: torch.randn(*s, dtype=torch.bfloat16) * 3.2)(D, F) * (D ** -0.5)),
        "w2": _w((lambda *s: torch.randn(*s, dtype=torch.bfloat16) * 3.2)(F, D) * (F ** -0.5)),
    }

def reference(x, w1, w2):
    h = torch.einsum("bsd,df->bsf", x, w1)
    h = _silu(h)
    out = torch.einsum("bsf,fd->bsd", h, w2)
    return out
```

```asm
; @launch grid=(256,1,1) block=(512,1,1) lds=151552
.amdgcn_target "amdgcn-amd-amdhsa--gfx950"
.text
.globl standalone__dense_activation_silu__sampling_kernel
.p2align 8
.type standalone__dense_activation_silu__sampling_kernel,@function
standalone__dense_activation_silu__sampling_kernel:
s_cmp_ge_u32 s2, 256
s_cbranch_scc1 L_END
s_load_dwordx8 s[4:11], s[0:1], 0
s_load_dwordx4 s[12:15], s[0:1], 32
v_lshrrev_b32 v1, 6, v0
v_and_b32 v0, 63, v0
v_readfirstlane_b32 s28, v1
s_and_b32 s29, s2, 7
s_lshr_b32 s30, s2, 3
s_and_b32 s30, s30, 3
s_lshr_b32 s31, s2, 5
s_nop 0
s_and_b32 s32, s28, 3
s_cmp_lt_u32 s28, 4
s_cbranch_scc1 L_COMPUTE
L_LOADER:
v_lshrrev_b32 v14, 3, v0
v_lshrrev_b32 v15, 4, v0
v_and_b32 v16, 7, v0
v_xor_b32 v15, v15, v16
v_lshlrev_b32 v15, 4, v15
v_mul_u32_u24 v14, 1152, v14
v_add_u32 v11, v14, v15
v_xor_b32 v15, 64, v15
v_add_u32 v14, 9216, v14
v_add_u32 v12, v14, v15
s_lshl_b32 s36, s31, 2
s_add_u32 s36, s36, s32
s_mul_i32 s49, s36, 18432
s_lshr_b32 s36, s32, 1
s_mul_i32 s50, s36, 20480
s_and_b32 s36, s32, 1
s_lshl_b32 s36, s36, 11
s_add_u32 s50, s50, s36
s_add_u32 s50, s50, 110592
s_mov_b32 s86, s50
s_add_u32 s87, s50, 20480
s_lshl_b32 s48, s30, 1
s_add_u32 s48, s48, s31
s_sub_u32 s36, s48, 9
s_cmp_ge_u32 s48, 9
s_cselect_b32 s48, s36, s48
s_mul_i32 s51, s29, 1152
s_mul_i32 s36, s30, 288
s_add_u32 s51, s51, s36
s_lshr_b32 s36, s32, 1
s_lshl_b32 s36, s36, 3
s_and_b32 s37, s32, 1
s_add_u32 s36, s36, s37
s_mul_i32 s36, s36, 36864
s_add_u32 s51, s51, s36
s_mul_i32 s52, s32, 4608
s_mov_b32 s35, 0
s_movk_i32 s37, -288
s_movk_i32 s38, 9216
v_add_u32 v14, 0, v0
v_mul_u32_u24 v15, 3641, v14
v_lshrrev_b32 v20, 16, v15
v_lshlrev_b32 v14, 4, v14
v_mad_i32_i24 v25, v20, s37, v14
v_and_b32 v15, 0xfc, v20
v_add_u32 v15, v15, v20
v_mad_u32_u24 v1, v15, s38, v25
s_waitcnt lgkmcnt(0)
s_mov_b32 s16, s4
s_mov_b32 s17, s5
s_mov_b32 s18, 589824
s_mov_b32 s19, 0x20000
s_mov_b32 s20, s6
s_mov_b32 s21, s7
s_mov_b32 s22, 5308416
s_mov_b32 s23, 0x20000
s_lshl_b32 s36, s48, 7
s_mov_b32 m0, s50
s_add_u32 s36, s36, s49
buffer_load_dwordx4 v11, s[16:19], s36 offen lds
s_add_u32 m0, m0, 1024
s_add_u32 s50, s50, 4096
buffer_load_dwordx4 v12, s[16:19], s36 offen lds
s_cmp_eq_u32 s50, s87
s_cselect_b32 s50, s86, s50
s_mul_i32 s34, s48, 589824
s_add_u32 s34, s34, s51
s_add_u32 m0, s35, s52
s_nop 0
buffer_load_dwordx4 v1, s[20:23], s34 offen lds
v_add_u32 v14, 64, v0
v_mul_u32_u24 v15, 3641, v14
v_lshrrev_b32 v21, 16, v15
v_lshlrev_b32 v14, 4, v14
v_mad_i32_i24 v26, v21, s37, v14
v_and_b32 v15, 0xfc, v21
v_add_u32 v15, v15, v21
v_mad_u32_u24 v2, v15, s38, v26
s_add_u32 m0, m0, 1024
s_nop 0
buffer_load_dwordx4 v2, s[20:23], s34 offen lds
v_add_u32 v14, 128, v0
v_mul_u32_u24 v15, 3641, v14
v_lshrrev_b32 v22, 16, v15
v_lshlrev_b32 v14, 4, v14
v_mad_i32_i24 v27, v22, s37, v14
v_and_b32 v15, 0xfc, v22
v_add_u32 v15, v15, v22
v_mad_u32_u24 v3, v15, s38, v27
s_add_u32 m0, m0, 1024
s_nop 0
buffer_load_dwordx4 v3, s[20:23], s34 offen lds
v_add_u32 v14, 192, v0
v_mul_u32_u24 v15, 3641, v14
v_lshrrev_b32 v23, 16, v15
v_lshlrev_b32 v14, 4, v14
v_mad_i32_i24 v28, v23, s37, v14
v_and_b32 v15, 0xfc, v23
v_add_u32 v15, v15, v23
v_mad_u32_u24 v4, v15, s38, v28
s_add_u32 m0, m0, 1024
s_nop 0
buffer_load_dwordx4 v4, s[20:23], s34 offen lds
v_add_u32 v14, 256, v0
v_mul_u32_u24 v15, 3641, v14
v_lshrrev_b32 v24, 16, v15
v_lshlrev_b32 v14, 4, v14
v_mad_i32_i24 v29, v24, s37, v14
v_and_b32 v15, 0xfc, v24
v_add_u32 v15, v15, v24
v_mad_u32_u24 v5, v15, s38, v29
s_add_u32 m0, m0, 1024
s_mov_b32 exec_hi, 0
buffer_load_dwordx4 v5, s[20:23], s34 offen lds
s_mov_b32 exec_hi, -1
s_add_u32 s35, s35, 18432
s_cmp_eq_u32 s35, 110592
s_cselect_b32 s35, 0, s35
s_add_u32 s48, s48, 1
s_sub_u32 s39, s48, 9
s_cmp_ge_u32 s48, 9
s_cselect_b32 s48, s39, s48
s_mov_b32 s40, s8
s_mov_b32 s41, s9
s_mov_b32 s42, 5308416
s_mov_b32 s43, 0x20000
s_lshl_b32 s36, s31, 2
s_add_u32 s36, s36, s30
s_mul_i32 s36, s36, 162
s_mul_i32 s37, s32, 41
s_add_u32 s36, s36, s37
s_lshl_b32 s36, s36, 7
s_mul_i32 s55, s29, 663552
s_add_u32 s95, s36, s55
v_min_u32 v30, 40, v0
v_lshlrev_b32 v30, 7, v30
s_mov_b32 s97, 1
s_add_u32 s93, s31, 2
s_min_u32 s93, s93, 8
s_lshl_b32 s36, s48, 7
s_mov_b32 m0, s50
s_add_u32 s36, s36, s49
buffer_load_dwordx4 v11, s[16:19], s36 offen lds
s_add_u32 m0, m0, 1024
s_add_u32 s50, s50, 4096
buffer_load_dwordx4 v12, s[16:19], s36 offen lds
s_cmp_eq_u32 s50, s87
s_cselect_b32 s50, s86, s50
s_mul_i32 s34, s48, 589824
s_add_u32 s34, s34, s51
s_add_u32 m0, s35, s52
s_nop 0
buffer_load_dwordx4 v1, s[20:23], s34 offen lds
s_add_u32 m0, m0, 1024
s_nop 0
buffer_load_dwordx4 v2, s[20:23], s34 offen lds
s_add_u32 m0, m0, 1024
s_nop 0
buffer_load_dwordx4 v3, s[20:23], s34 offen lds
s_add_u32 m0, m0, 1024
s_nop 0
buffer_load_dwordx4 v4, s[20:23], s34 offen lds
s_add_u32 m0, m0, 1024
s_mov_b32 exec_hi, 0
buffer_load_dwordx4 v5, s[20:23], s34 offen lds
s_mov_b32 exec_hi, -1
s_add_u32 s35, s35, 18432
s_cmp_eq_u32 s35, 110592
s_cselect_b32 s35, 0, s35
s_add_u32 s48, s48, 1
s_sub_u32 s39, s48, 9
s_cmp_ge_u32 s48, 9
s_cselect_b32 s48, s39, s48
s_cmp_eq_u32 s97, s93
s_cselect_b32 s96, s95, 0x70000000
s_add_u32 s97, s97, 1
buffer_load_dword v31, v30, s[40:43], s96 offen
s_mov_b32 s24, s14
s_mov_b32 s25, s15
s_mov_b32 s26, 268435456
s_mov_b32 s27, 0x20000
s_mov_b32 s44, s12
s_mov_b32 s45, s13
s_mov_b32 s46, 256
s_mov_b32 s47, 0x20000
s_movk_i32 s38, 1152
v_and_b32 v14, 1, v20
v_lshrrev_b32 v15, 3, v20
v_lshlrev_b32 v15, 2, v15
v_lshl_add_u32 v15, v14, 3, v15
v_bfe_u32 v14, v20, 1, 2
v_add_u32 v15, v15, v14
v_mad_u32_u24 v6, v15, s38, v25
v_and_b32 v14, 1, v21
v_lshrrev_b32 v15, 3, v21
v_lshlrev_b32 v15, 2, v15
v_lshl_add_u32 v15, v14, 3, v15
v_bfe_u32 v14, v21, 1, 2
v_add_u32 v15, v15, v14
v_mad_u32_u24 v7, v15, s38, v26
v_and_b32 v14, 1, v22
v_lshrrev_b32 v15, 3, v22
v_lshlrev_b32 v15, 2, v15
v_lshl_add_u32 v15, v14, 3, v15
v_bfe_u32 v14, v22, 1, 2
v_add_u32 v15, v15, v14
v_mad_u32_u24 v8, v15, s38, v27
v_and_b32 v14, 1, v23
v_lshrrev_b32 v15, 3, v23
v_lshlrev_b32 v15, 2, v15
v_lshl_add_u32 v15, v14, 3, v15
v_bfe_u32 v14, v23, 1, 2
v_add_u32 v15, v15, v14
v_mad_u32_u24 v9, v15, s38, v28
v_and_b32 v14, 1, v24
v_lshrrev_b32 v15, 3, v24
v_lshlrev_b32 v15, 2, v15
v_lshl_add_u32 v15, v14, 3, v15
v_bfe_u32 v14, v24, 1, 2
v_add_u32 v15, v15, v14
v_mad_u32_u24 v10, v15, s38, v29
s_lshl_b32 s54, s29, 3
s_add_u32 s54, s54, s31
s_lshr_b32 s53, s54, 4
s_lshl_b32 s53, s53, 21
s_and_b32 s36, s54, 15
s_mul_i32 s36, s36, 73728
s_add_u32 s53, s53, s36
s_add_u32 s53, s53, 4096
s_lshl_b32 s54, s54, 2
s_mul_i32 s36, s30, 288
s_add_u32 s55, s55, s36
s_mul_i32 s56, s30, 9
s_add_u32 s56, s56, s32
s_add_u32 s92, s56, 8
s_sub_u32 s36, s92, 36
s_cmp_ge_u32 s92, 36
s_cselect_b32 s92, s36, s92
s_lshl_b32 s94, s32, 10
s_add_u32 s94, s94, 118784
v_lshlrev_b32 v13, 4, v0
s_lshl_b32 s58, s31, 2
s_add_u32 s58, s58, s30
s_mul_i32 s58, s58, 147456
s_add_u32 s58, s58, 10489856
s_mul_i32 s37, s29, 18432
s_add_u32 s58, s58, s37
v_bfe_u32 v32, v0, 2, 2
v_lshlrev_b32 v32, 6, v32
v_and_b32 v33, 3, v0
v_lshl_add_u32 v32, v33, 2, v32
v_lshrrev_b32 v34, 2, v0
v_and_b32 v34, 7, v34
v_lshlrev_b32 v34, 11, v34
v_and_b32 v35, 3, v0
v_lshl_add_u32 v34, v35, 2, v34
s_lshl_b32 s59, s31, 8
s_lshl_b32 s36, s30, 6
s_add_u32 s59, s59, s36
s_add_u32 s59, s59, 8392704
s_waitcnt vmcnt(8)
s_barrier
s_lshl_b32 s36, s48, 7
s_mov_b32 m0, s50
s_add_u32 s36, s36, s49
buffer_load_dwordx4 v11, s[16:19], s36 offen lds
s_add_u32 m0, m0, 1024
s_add_u32 s50, s50, 4096
buffer_load_dwordx4 v12, s[16:19], s36 offen lds
s_cmp_eq_u32 s50, s87
s_cselect_b32 s50, s86, s50
s_mul_i32 s34, s48, 589824
s_add_u32 s34, s34, s51
s_add_u32 m0, s35, s52
s_nop 0
buffer_load_dwordx4 v1, s[20:23], s34 offen lds
s_add_u32 m0, m0, 1024
s_nop 0
buffer_load_dwordx4 v2, s[20:23], s34 offen lds
s_add_u32 m0, m0, 1024
s_nop 0
buffer_load_dwordx4 v3, s[20:23], s34 offen lds
s_add_u32 m0, m0, 1024
s_nop 0
buffer_load_dwordx4 v4, s[20:23], s34 offen lds
s_add_u32 m0, m0, 1024
s_mov_b32 exec_hi, 0
buffer_load_dwordx4 v5, s[20:23], s34 offen lds
s_mov_b32 exec_hi, -1
s_add_u32 s35, s35, 18432
s_cmp_eq_u32 s35, 110592
s_cselect_b32 s35, 0, s35
s_add_u32 s48, s48, 1
s_sub_u32 s39, s48, 9
s_cmp_ge_u32 s48, 9
s_cselect_b32 s48, s39, s48
s_cmp_eq_u32 s97, s93
s_cselect_b32 s96, s95, 0x70000000
s_add_u32 s97, s97, 1
buffer_load_dword v31, v30, s[40:43], s96 offen
s_mov_b32 s33, 0
L_LD1:
s_waitcnt vmcnt(9)
s_barrier
s_lshl_b32 s36, s48, 7
s_mov_b32 m0, s50
s_add_u32 s36, s36, s49
buffer_load_dwordx4 v11, s[16:19], s36 offen lds
s_add_u32 m0, m0, 1024
s_add_u32 s50, s50, 4096
buffer_load_dwordx4 v12, s[16:19], s36 offen lds
s_cmp_eq_u32 s50, s87
s_cselect_b32 s50, s86, s50
s_mul_i32 s34, s48, 589824
s_add_u32 s34, s34, s51
s_add_u32 m0, s35, s52
s_nop 0
buffer_load_dwordx4 v1, s[20:23], s34 offen lds
s_add_u32 m0, m0, 1024
s_nop 0
buffer_load_dwordx4 v2, s[20:23], s34 offen lds
s_add_u32 m0, m0, 1024
s_nop 0
buffer_load_dwordx4 v3, s[20:23], s34 offen lds
s_add_u32 m0, m0, 1024
s_nop 0
buffer_load_dwordx4 v4, s[20:23], s34 offen lds
s_add_u32 m0, m0, 1024
s_mov_b32 exec_hi, 0
buffer_load_dwordx4 v5, s[20:23], s34 offen lds
s_mov_b32 exec_hi, -1
s_add_u32 s35, s35, 18432
s_cmp_eq_u32 s35, 110592
s_cselect_b32 s35, 0, s35
s_add_u32 s48, s48, 1
s_sub_u32 s39, s48, 9
s_cmp_ge_u32 s48, 9
s_cselect_b32 s48, s39, s48
s_cmp_eq_u32 s97, s93
s_cselect_b32 s96, s95, 0x70000000
s_add_u32 s97, s97, 1
buffer_load_dword v31, v30, s[40:43], s96 offen
s_add_u32 s33, s33, 1
s_cmp_lt_u32 s33, 6
s_cbranch_scc1 L_LD1
s_mov_b32 s35, 73728
s_lshl_b32 s86, s32, 10
s_add_u32 s86, s86, 110592
s_add_u32 s87, s86, 20480
s_waitcnt vmcnt(9)
s_barrier
s_mul_i32 s34, s56, 18432
s_add_u32 s34, s34, s55
s_add_u32 m0, s35, s52
s_nop 0
buffer_load_dwordx4 v6, s[40:43], s34 offen lds
s_add_u32 m0, m0, 1024
s_nop 0
buffer_load_dwordx4 v7, s[40:43], s34 offen lds
s_add_u32 m0, m0, 1024
s_nop 0
buffer_load_dwordx4 v8, s[40:43], s34 offen lds
s_add_u32 m0, m0, 1024
s_nop 0
buffer_load_dwordx4 v9, s[40:43], s34 offen lds
s_add_u32 m0, m0, 1024
s_mov_b32 exec_hi, 0
buffer_load_dwordx4 v10, s[40:43], s34 offen lds
s_mov_b32 exec_hi, -1
s_add_u32 s35, s35, 18432
s_cmp_eq_u32 s35, 110592
s_cselect_b32 s35, 0, s35
s_add_u32 s56, s56, 4
s_sub_u32 s39, s56, 36
s_cmp_ge_u32 s56, 36
s_cselect_b32 s56, s39, s56
s_waitcnt vmcnt(6)
s_barrier
s_mul_i32 s34, s56, 18432
s_add_u32 s34, s34, s55
s_add_u32 m0, s35, s52
s_nop 0
buffer_load_dwordx4 v6, s[40:43], s34 offen lds
s_add_u32 m0, m0, 1024
s_nop 0
buffer_load_dwordx4 v7, s[40:43], s34 offen lds
s_add_u32 m0, m0, 1024
s_nop 0
buffer_load_dwordx4 v8, s[40:43], s34 offen lds
s_add_u32 m0, m0, 1024
s_nop 0
buffer_load_dwordx4 v9, s[40:43], s34 offen lds
s_add_u32 m0, m0, 1024
s_mov_b32 exec_hi, 0
buffer_load_dwordx4 v10, s[40:43], s34 offen lds
s_mov_b32 exec_hi, -1
s_add_u32 s35, s35, 18432
s_cmp_eq_u32 s35, 110592
s_cselect_b32 s35, 0, s35
s_add_u32 s56, s56, 4
s_sub_u32 s39, s56, 36
s_cmp_ge_u32 s56, 36
s_cselect_b32 s56, s39, s56
s_barrier
s_mul_i32 s34, s56, 18432
s_add_u32 s34, s34, s55
s_add_u32 m0, s35, s52
s_nop 0
buffer_load_dwordx4 v6, s[40:43], s34 offen lds
s_add_u32 m0, m0, 1024
s_nop 0
buffer_load_dwordx4 v7, s[40:43], s34 offen lds
s_add_u32 m0, m0, 1024
s_nop 0
buffer_load_dwordx4 v8, s[40:43], s34 offen lds
s_add_u32 m0, m0, 1024
s_nop 0
buffer_load_dwordx4 v9, s[40:43], s34 offen lds
s_add_u32 m0, m0, 1024
s_mov_b32 exec_hi, 0
buffer_load_dwordx4 v10, s[40:43], s34 offen lds
s_mov_b32 exec_hi, -1
s_add_u32 s35, s35, 18432
s_cmp_eq_u32 s35, 110592
s_cselect_b32 s35, 0, s35
s_add_u32 s56, s56, 4
s_sub_u32 s39, s56, 36
s_cmp_ge_u32 s56, 36
s_cselect_b32 s56, s39, s56
buffer_load_dword v14, off, s[44:47], 0 sc1
s_lshl_b32 s38, s54, 6
s_add_u32 s38, s38, 8392704
s_waitcnt vmcnt(11)
s_barrier
s_mul_i32 s34, s56, 18432
s_add_u32 s34, s34, s55
s_add_u32 m0, s35, s52
s_nop 0
buffer_load_dwordx4 v6, s[40:43], s34 offen lds
s_add_u32 m0, m0, 1024
s_nop 0
buffer_load_dwordx4 v7, s[40:43], s34 offen lds
s_add_u32 m0, m0, 1024
s_nop 0
buffer_load_dwordx4 v8, s[40:43], s34 offen lds
s_add_u32 m0, m0, 1024
s_nop 0
buffer_load_dwordx4 v9, s[40:43], s34 offen lds
s_add_u32 m0, m0, 1024
s_mov_b32 exec_hi, 0
buffer_load_dwordx4 v10, s[40:43], s34 offen lds
s_mov_b32 exec_hi, -1
s_add_u32 s35, s35, 18432
s_cmp_eq_u32 s35, 110592
s_cselect_b32 s35, 0, s35
s_add_u32 s56, s56, 4
s_sub_u32 s39, s56, 36
s_cmp_ge_u32 s56, 36
s_cselect_b32 s56, s39, s56
s_waitcnt vmcnt(11)
s_barrier
s_mul_i32 s34, s56, 18432
s_add_u32 s34, s34, s55
s_add_u32 m0, s35, s52
s_nop 0
buffer_load_dwordx4 v6, s[40:43], s34 offen lds
s_add_u32 m0, m0, 1024
s_nop 0
buffer_load_dwordx4 v7, s[40:43], s34 offen lds
s_add_u32 m0, m0, 1024
s_nop 0
buffer_load_dwordx4 v8, s[40:43], s34 offen lds
s_add_u32 m0, m0, 1024
s_nop 0
buffer_load_dwordx4 v9, s[40:43], s34 offen lds
s_add_u32 m0, m0, 1024
s_mov_b32 exec_hi, 0
buffer_load_dwordx4 v10, s[40:43], s34 offen lds
s_mov_b32 exec_hi, -1
s_add_u32 s35, s35, 18432
s_cmp_eq_u32 s35, 110592
s_cselect_b32 s35, 0, s35
s_add_u32 s56, s56, 4
s_sub_u32 s39, s56, 36
s_cmp_ge_u32 s56, 36
s_cselect_b32 s56, s39, s56
s_mul_i32 s34, s56, 18432
s_add_u32 s34, s34, s55
s_add_u32 m0, s35, s52
s_nop 0
buffer_load_dwordx4 v6, s[40:43], s34 offen lds
s_add_u32 m0, m0, 1024
s_nop 0
buffer_load_dwordx4 v7, s[40:43], s34 offen lds
s_add_u32 m0, m0, 1024
s_nop 0
buffer_load_dwordx4 v8, s[40:43], s34 offen lds
s_add_u32 m0, m0, 1024
s_nop 0
buffer_load_dwordx4 v9, s[40:43], s34 offen lds
s_add_u32 m0, m0, 1024
s_mov_b32 exec_hi, 0
buffer_load_dwordx4 v10, s[40:43], s34 offen lds
s_mov_b32 exec_hi, -1
s_add_u32 s35, s35, 18432
s_cmp_eq_u32 s35, 110592
s_cselect_b32 s35, 0, s35
s_add_u32 s56, s56, 4
s_sub_u32 s39, s56, 36
s_cmp_ge_u32 s56, 36
s_cselect_b32 s56, s39, s56
s_waitcnt vmcnt(0)
v_cmp_ne_u32 vcc, 1, v14
s_cbranch_vccz L_PGXL
s_mov_b32 s39, 0
L_PGL:
s_add_u32 s39, s39, 1
s_cmp_gt_u32 s39, 131072
s_cbranch_scc1 L_PGXL
buffer_load_dword v14, off, s[44:47], 0 sc1
s_waitcnt vmcnt(0)
v_cmp_ne_u32 vcc, 1, v14
s_cbranch_vccnz L_PGL
L_PGXL:
s_cmp_eq_u32 s32, 0
s_cbranch_scc0 L_POXF
s_mov_b32 s39, 0
L_POF:
s_add_u32 s39, s39, 1
s_cmp_gt_u32 s39, 131072
s_cbranch_scc1 L_POXF
buffer_load_dword v14, v32, s[24:27], s38 offen sc1
s_waitcnt vmcnt(0)
v_cmp_ne_u32 vcc, 1, v14
s_cbranch_vccnz L_POF
L_POXF:
s_barrier
s_lshl_b32 s57, s92, 10
s_mov_b32 m0, s94
s_add_u32 s57, s57, s53
buffer_load_dwordx4 v13, s[24:27], s57 offen sc1 lds
s_add_u32 m0, m0, 20480
s_add_u32 s57, s57, 36864
buffer_load_dwordx4 v13, s[24:27], s57 offen sc1 lds
s_add_u32 s94, s94, 4096
s_cmp_eq_u32 s94, s87
s_cselect_b32 s94, s86, s94
s_add_u32 s92, s92, 4
s_sub_u32 s39, s92, 36
s_cmp_ge_u32 s92, 36
s_cselect_b32 s92, s39, s92
s_lshl_b32 s57, s92, 10
s_mov_b32 m0, s94
s_add_u32 s57, s57, s53
buffer_load_dwordx4 v13, s[24:27], s57 offen sc1 lds
s_add_u32 m0, m0, 20480
s_add_u32 s57, s57, 36864
buffer_load_dwordx4 v13, s[24:27], s57 offen sc1 lds
s_add_u32 s94, s94, 4096
s_cmp_eq_u32 s94, s87
s_cselect_b32 s94, s86, s94
s_add_u32 s92, s92, 4
s_sub_u32 s39, s92, 36
s_cmp_ge_u32 s92, 36
s_cselect_b32 s92, s39, s92
s_lshl_b32 s57, s92, 10
s_mov_b32 m0, s94
s_add_u32 s57, s57, s53
buffer_load_dwordx4 v13, s[24:27], s57 offen sc1 lds
s_add_u32 m0, m0, 20480
s_add_u32 s57, s57, 36864
buffer_load_dwordx4 v13, s[24:27], s57 offen sc1 lds
s_add_u32 s94, s94, 4096
s_cmp_eq_u32 s94, s87
s_cselect_b32 s94, s86, s94
s_add_u32 s92, s92, 4
s_sub_u32 s39, s92, 36
s_cmp_ge_u32 s92, 36
s_cselect_b32 s92, s39, s92
s_waitcnt vmcnt(4)
s_barrier
s_lshl_b32 s57, s92, 10
s_mov_b32 m0, s94
s_add_u32 s57, s57, s53
buffer_load_dwordx4 v13, s[24:27], s57 offen sc1 lds
s_add_u32 m0, m0, 20480
s_add_u32 s57, s57, 36864
buffer_load_dwordx4 v13, s[24:27], s57 offen sc1 lds
s_add_u32 s94, s94, 4096
s_cmp_eq_u32 s94, s87
s_cselect_b32 s94, s86, s94
s_add_u32 s92, s92, 4
s_sub_u32 s39, s92, 36
s_cmp_ge_u32 s92, 36
s_cselect_b32 s92, s39, s92
s_mul_i32 s34, s56, 18432
s_add_u32 s34, s34, s55
s_add_u32 m0, s35, s52
s_nop 0
buffer_load_dwordx4 v6, s[40:43], s34 offen lds
s_add_u32 m0, m0, 1024
s_nop 0
buffer_load_dwordx4 v7, s[40:43], s34 offen lds
s_add_u32 m0, m0, 1024
s_nop 0
buffer_load_dwordx4 v8, s[40:43], s34 offen lds
s_add_u32 m0, m0, 1024
s_nop 0
buffer_load_dwordx4 v9, s[40:43], s34 offen lds
s_add_u32 m0, m0, 1024
s_mov_b32 exec_hi, 0
buffer_load_dwordx4 v10, s[40:43], s34 offen lds
s_mov_b32 exec_hi, -1
s_add_u32 s35, s35, 18432
s_cmp_eq_u32 s35, 110592
s_cselect_b32 s35, 0, s35
s_add_u32 s56, s56, 4
s_sub_u32 s39, s56, 36
s_cmp_ge_u32 s56, 36
s_cselect_b32 s56, s39, s56
s_waitcnt vmcnt(9)
s_barrier
s_lshl_b32 s57, s92, 10
s_mov_b32 m0, s94
s_add_u32 s57, s57, s53
buffer_load_dwordx4 v13, s[24:27], s57 offen sc1 lds
s_add_u32 m0, m0, 20480
s_add_u32 s57, s57, 36864
buffer_load_dwordx4 v13, s[24:27], s57 offen sc1 lds
s_add_u32 s94, s94, 4096
s_cmp_eq_u32 s94, s87
s_cselect_b32 s94, s86, s94
s_add_u32 s92, s92, 4
s_sub_u32 s39, s92, 36
s_cmp_ge_u32 s92, 36
s_cselect_b32 s92, s39, s92
s_mul_i32 s34, s56, 18432
s_add_u32 s34, s34, s55
s_add_u32 m0, s35, s52
s_nop 0
buffer_load_dwordx4 v6, s[40:43], s34 offen lds
s_add_u32 m0, m0, 1024
s_nop 0
buffer_load_dwordx4 v7, s[40:43], s34 offen lds
s_add_u32 m0, m0, 1024
s_nop 0
buffer_load_dwordx4 v8, s[40:43], s34 offen lds
s_add_u32 m0, m0, 1024
s_nop 0
buffer_load_dwordx4 v9, s[40:43], s34 offen lds
s_add_u32 m0, m0, 1024
s_mov_b32 exec_hi, 0
buffer_load_dwordx4 v10, s[40:43], s34 offen lds
s_mov_b32 exec_hi, -1
s_add_u32 s35, s35, 18432
s_cmp_eq_u32 s35, 110592
s_cselect_b32 s35, 0, s35
s_add_u32 s56, s56, 4
s_sub_u32 s39, s56, 36
s_cmp_ge_u32 s56, 36
s_cselect_b32 s56, s39, s56
s_waitcnt vmcnt(14)
s_barrier
s_lshl_b32 s57, s92, 10
s_mov_b32 m0, s94
s_add_u32 s57, s57, s53
buffer_load_dwordx4 v13, s[24:27], s57 offen sc1 lds
s_add_u32 m0, m0, 20480
s_add_u32 s57, s57, 36864
buffer_load_dwordx4 v13, s[24:27], s57 offen sc1 lds
s_add_u32 s94, s94, 4096
s_cmp_eq_u32 s94, s87
s_cselect_b32 s94, s86, s94
s_add_u32 s92, s92, 4
s_sub_u32 s39, s92, 36
s_cmp_ge_u32 s92, 36
s_cselect_b32 s92, s39, s92
s_mul_i32 s34, s56, 18432
s_add_u32 s34, s34, s55
s_add_u32 m0, s35, s52
s_nop 0
buffer_load_dwordx4 v6, s[40:43], s34 offen lds
s_add_u32 m0, m0, 1024
s_nop 0
buffer_load_dwordx4 v7, s[40:43], s34 offen lds
s_add_u32 m0, m0, 1024
s_nop 0
buffer_load_dwordx4 v8, s[40:43], s34 offen lds
s_add_u32 m0, m0, 1024
s_nop 0
buffer_load_dwordx4 v9, s[40:43], s34 offen lds
s_add_u32 m0, m0, 1024
s_mov_b32 exec_hi, 0
buffer_load_dwordx4 v10, s[40:43], s34 offen lds
s_mov_b32 exec_hi, -1
s_add_u32 s35, s35, 18432
s_cmp_eq_u32 s35, 110592
s_cselect_b32 s35, 0, s35
s_add_u32 s56, s56, 4
s_sub_u32 s39, s56, 36
s_cmp_ge_u32 s56, 36
s_cselect_b32 s56, s39, s56
s_waitcnt vmcnt(19)
s_barrier
s_lshl_b32 s57, s92, 10
s_mov_b32 m0, s94
s_add_u32 s57, s57, s53
buffer_load_dwordx4 v13, s[24:27], s57 offen sc1 lds
s_add_u32 m0, m0, 20480
s_add_u32 s57, s57, 36864
buffer_load_dwordx4 v13, s[24:27], s57 offen sc1 lds
s_add_u32 s94, s94, 4096
s_cmp_eq_u32 s94, s87
s_cselect_b32 s94, s86, s94
s_add_u32 s92, s92, 4
s_sub_u32 s39, s92, 36
s_cmp_ge_u32 s92, 36
s_cselect_b32 s92, s39, s92
buffer_load_dword v35, v34, s[24:27], s59 offen sc1
s_waitcnt vmcnt(15)
s_barrier
s_waitcnt vmcnt(8)
s_barrier
s_waitcnt vmcnt(0)
v_cmp_ne_u32 vcc, 1, v35
s_cbranch_vccz L_POXK
s_mov_b32 s39, 0
L_POK:
s_add_u32 s39, s39, 1
s_cmp_gt_u32 s39, 131072
s_cbranch_scc1 L_POXK
buffer_load_dword v35, v34, s[24:27], s59 offen sc1
s_waitcnt vmcnt(0)
v_cmp_ne_u32 vcc, 1, v35
s_cbranch_vccnz L_POK
L_POXK:
s_waitcnt vmcnt(0)
s_barrier
v_lshlrev_b32 v104, 3, v0
s_lshl_b32 s36, s32, 9
s_add_u32 s36, s36, s58
v_bfe_u32 v100, v0, 1, 3
v_mul_u32_u24 v100, 1152, v100
v_lshrrev_b32 v101, 5, v0
v_lshl_add_u32 v100, v101, 5, v100
v_and_b32 v101, 1, v0
v_lshl_add_u32 v100, v101, 4, v100
v_bfe_u32 v101, v0, 4, 1
v_lshl_add_u32 v105, v101, 3, v100
s_lshl_b32 s38, s32, 6
s_lshl_b32 s37, s31, 3
s_add_u32 s37, s37, s29
s_mul_i32 s37, s37, 9216
s_add_u32 s38, s38, s37
s_mul_i32 s37, s30, 288
s_add_u32 s38, s38, s37
s_mov_b32 s16, s10
s_mov_b32 s17, s11
s_mov_b32 s18, 589824
s_mov_b32 s19, 0x20000
s_barrier
s_mov_b32 s39, 0
L_RPL:
s_mov_b32 s37, s36
buffer_load_dwordx2 v[80:81], v104, s[24:27], s37 offen sc1
s_add_u32 s37, s37, 2304
buffer_load_dwordx2 v[82:83], v104, s[24:27], s37 offen sc1
s_add_u32 s37, s37, 2304
buffer_load_dwordx2 v[84:85], v104, s[24:27], s37 offen sc1
s_add_u32 s37, s37, 2304
buffer_load_dwordx2 v[86:87], v104, s[24:27], s37 offen sc1
s_add_u32 s37, s37, 2304
buffer_load_dwordx2 v[88:89], v104, s[24:27], s37 offen sc1
s_add_u32 s37, s37, 2304
buffer_load_dwordx2 v[90:91], v104, s[24:27], s37 offen sc1
s_add_u32 s37, s37, 2304
buffer_load_dwordx2 v[92:93], v104, s[24:27], s37 offen sc1
s_add_u32 s37, s37, 2304
buffer_load_dwordx2 v[94:95], v104, s[24:27], s37 offen sc1
s_add_u32 s39, s39, 1
s_cmp_gt_u32 s39, 131072
s_cbranch_scc1 L_RPXL
s_waitcnt vmcnt(0)
v_max3_u32 v100, v80, v81, v82
v_max3_u32 v100, v100, v83, v84
v_max3_u32 v100, v100, v85, v86
v_max3_u32 v100, v100, v87, v88
v_max3_u32 v100, v100, v89, v90
v_max3_u32 v100, v100, v91, v92
v_max3_u32 v100, v100, v93, v94
v_max_u32 v100, v100, v95
v_cmp_eq_u32 vcc, -1, v100
s_cbranch_vccnz L_RPL
L_RPXL:
s_waitcnt vmcnt(0)
v_lshlrev_b32 v96, 16, v80
v_and_b32 v97, 0xffff0000, v80
v_lshlrev_b32 v98, 16, v81
v_and_b32 v99, 0xffff0000, v81
v_lshlrev_b32 v100, 16, v82
v_and_b32 v101, 0xffff0000, v82
v_lshlrev_b32 v102, 16, v83
v_and_b32 v103, 0xffff0000, v83
v_add_f32 v96, v96, v100
v_add_f32 v97, v97, v101
v_add_f32 v98, v98, v102
v_add_f32 v99, v99, v103
v_lshlrev_b32 v100, 16, v84
v_and_b32 v101, 0xffff0000, v84
v_lshlrev_b32 v102, 16, v85
v_and_b32 v103, 0xffff0000, v85
v_add_f32 v96, v96, v100
v_add_f32 v97, v97, v101
v_add_f32 v98, v98, v102
v_add_f32 v99, v99, v103
v_lshlrev_b32 v100, 16, v86
v_and_b32 v101, 0xffff0000, v86
v_lshlrev_b32 v102, 16, v87
v_and_b32 v103, 0xffff0000, v87
v_add_f32 v96, v96, v100
v_add_f32 v97, v97, v101
v_add_f32 v98, v98, v102
v_add_f32 v99, v99, v103
v_lshlrev_b32 v100, 16, v88
v_and_b32 v101, 0xffff0000, v88
v_lshlrev_b32 v102, 16, v89
v_and_b32 v103, 0xffff0000, v89
v_add_f32 v96, v96, v100
v_add_f32 v97, v97, v101
v_add_f32 v98, v98, v102
v_add_f32 v99, v99, v103
v_lshlrev_b32 v100, 16, v90
v_and_b32 v101, 0xffff0000, v90
v_lshlrev_b32 v102, 16, v91
v_and_b32 v103, 0xffff0000, v91
v_add_f32 v96, v96, v100
v_add_f32 v97, v97, v101
v_add_f32 v98, v98, v102
v_add_f32 v99, v99, v103
v_lshlrev_b32 v100, 16, v92
v_and_b32 v101, 0xffff0000, v92
v_lshlrev_b32 v102, 16, v93
v_and_b32 v103, 0xffff0000, v93
v_add_f32 v96, v96, v100
v_add_f32 v97, v97, v101
v_add_f32 v98, v98, v102
v_add_f32 v99, v99, v103
v_lshlrev_b32 v100, 16, v94
v_and_b32 v101, 0xffff0000, v94
v_lshlrev_b32 v102, 16, v95
v_and_b32 v103, 0xffff0000, v95
v_add_f32 v96, v96, v100
v_add_f32 v97, v97, v101
v_add_f32 v98, v98, v102
v_add_f32 v99, v99, v103
v_cvt_pk_bf16_f32 v80, v96, v97
v_cvt_pk_bf16_f32 v81, v98, v99
buffer_store_dwordx2 v[80:81], v105, s[16:19], s38 offen
s_endpgm
L_COMPUTE:
s_and_b32 s36, s32, 1
s_lshr_b32 s37, s32, 1
v_lshrrev_b32 v12, 2, v0
v_mul_u32_u24 v12, 288, v12
v_and_b32 v13, 3, v0
v_lshl_add_u32 v12, v13, 3, v12
v_add_u32 v124, 256, v12
v_add_u32 v125, 36864, v124
v_add_u32 v126, 73728, v124
s_lshl_b32 s38, s36, 7
v_add_u32 v2, s38, v12
v_add_u32 v3, 36864, v2
v_add_u32 v4, 73728, v2
v_bfe_u32 v12, v0, 2, 2
v_mul_u32_u24 v12, 576, v12
v_lshl_add_u32 v12, v13, 3, v12
v_lshrrev_b32 v13, 4, v0
v_mul_u32_u24 v14, 2304, v13
v_add_u32 v14, v14, v12
v_add_u32 v129, 256, v14
v_lshrrev_b32 v14, 5, v0
v_mul_u32_u24 v14, 2304, v14
v_add_u32 v12, v12, v14
v_and_b32 v13, 1, v13
v_lshl_add_u32 v12, v13, 5, v12
s_lshl_b32 s38, s36, 7
v_add_u32 v128, s38, v12
s_mul_i32 s37, s37, 20480
s_add_u32 s37, s37, 110592
v_and_b32 v12, 15, v0
v_lshrrev_b32 v13, 1, v12
v_lshlrev_b32 v12, 7, v12
v_add_u32 v12, s37, v12
v_lshrrev_b32 v15, 4, v0
v_xor_b32 v15, v15, v13
v_lshlrev_b32 v15, 4, v15
v_add_u32 v6, v12, v15
v_xor_b32 v15, 64, v15
v_add_u32 v7, v12, v15
s_lshl_b32 s38, s36, 11
v_add_u32 v10, s38, v6
v_add_u32 v11, s38, v7
v_pk_mov_b32 v[80:81], 0, 0
v_pk_mov_b32 v[82:83], 0, 0
v_pk_mov_b32 v[84:85], 0, 0
v_pk_mov_b32 v[86:87], 0, 0
v_pk_mov_b32 v[88:89], 0, 0
v_pk_mov_b32 v[90:91], 0, 0
v_pk_mov_b32 v[92:93], 0, 0
v_pk_mov_b32 v[94:95], 0, 0
v_pk_mov_b32 v[96:97], 0, 0
v_pk_mov_b32 v[98:99], 0, 0
v_pk_mov_b32 v[100:101], 0, 0
v_pk_mov_b32 v[102:103], 0, 0
v_pk_mov_b32 v[104:105], 0, 0
v_pk_mov_b32 v[106:107], 0, 0
v_pk_mov_b32 v[108:109], 0, 0
v_pk_mov_b32 v[110:111], 0, 0
v_pk_mov_b32 v[112:113], 0, 0
v_pk_mov_b32 v[114:115], 0, 0
s_lshl_b32 s54, s29, 3
s_add_u32 s54, s54, s31
s_lshr_b32 s53, s54, 4
s_lshl_b32 s53, s53, 21
s_and_b32 s36, s54, 15
s_mul_i32 s36, s36, 73728
s_add_u32 s53, s53, s36
s_add_u32 s53, s53, 4096
s_lshl_b32 s54, s54, 2
s_lshl_b32 s52, s31, 2
s_add_u32 s52, s52, s30
s_mul_i32 s52, s52, 147456
s_add_u32 s52, s52, 10489856
s_mul_i32 s36, s29, 18432
s_add_u32 s58, s52, s36
s_mul_i32 s36, s29, 2304
s_add_u32 s52, s52, s36
s_mul_i32 s36, s32, 36864
s_add_u32 s55, s52, s36
s_add_u32 s55, s55, 2048
s_lshr_b32 s36, s32, 1
s_mul_i32 s36, s36, 73728
s_add_u32 s52, s52, s36
s_and_b32 s36, s32, 1
s_lshl_b32 s36, s36, 10
s_add_u32 s52, s52, s36
s_lshr_b32 s36, s32, 1
s_mul_i32 s36, s36, 36864
s_add_u32 s36, s36, s53
s_mul_i32 s37, s30, 9216
s_add_u32 s36, s36, s37
s_and_b32 s37, s32, 1
s_lshl_b32 s38, s37, 12
s_add_u32 s49, s36, s38
s_lshl_b32 s38, s37, 8
s_add_u32 s50, s36, s38
s_add_u32 s50, s50, 8192
s_lshl_b32 s51, s54, 6
s_lshl_b32 s36, s30, 4
s_add_u32 s36, s36, s32
s_lshl_b32 s36, s36, 2
s_add_u32 s51, s51, s36
s_add_u32 s51, s51, 8392704
s_mov_b32 s84, 0xbfb8aa3b
s_mov_b32 s85, 0xbfb8aa3b
s_mov_b32 s48, 0
s_waitcnt lgkmcnt(0)
s_mov_b32 s24, s14
s_mov_b32 s25, s15
s_mov_b32 s26, 268435456
s_mov_b32 s27, 0x20000
s_mov_b32 s44, s12
s_mov_b32 s45, s13
s_mov_b32 s46, 256
s_mov_b32 s47, 0x20000
v_lshlrev_b32 v116, 4, v0
s_mul_i32 s37, s32, 4608
s_add_u32 s36, s58, s37
v_mov_b32 v120, -1
v_mov_b32 v121, -1
v_mov_b32 v122, -1
v_mov_b32 v123, -1
v_lshlrev_b32 v116, 4, v0
v_min_u32 v117, 31, v0
v_lshlrev_b32 v117, 4, v117
buffer_store_dwordx4 v[120:123], v116, s[24:27], s36 offen offset:0 sc1
buffer_store_dwordx4 v[120:123], v116, s[24:27], s36 offen offset:1024 sc1
buffer_store_dwordx4 v[120:123], v116, s[24:27], s36 offen offset:2048 sc1
buffer_store_dwordx4 v[120:123], v116, s[24:27], s36 offen offset:3072 sc1
s_add_u32 s36, s36, 4096
buffer_store_dwordx4 v[120:123], v117, s[24:27], s36 offen sc1
s_cmp_eq_u32 s2, 0
s_cbranch_scc0 L_NOCLR
s_mul_i32 s36, s32, 4096
s_add_u32 s36, s36, 8392704
v_pk_mov_b32 v[48:49], 0, 0
v_pk_mov_b32 v[50:51], 0, 0
buffer_store_dwordx4 v[48:51], v116, s[24:27], s36 offen offset:0 sc1
buffer_store_dwordx4 v[48:51], v116, s[24:27], s36 offen offset:1024 sc1
buffer_store_dwordx4 v[48:51], v116, s[24:27], s36 offen offset:2048 sc1
buffer_store_dwordx4 v[48:51], v116, s[24:27], s36 offen offset:3072 sc1
L_NOCLR:
s_barrier
ds_read_b128 v[36:39], v6 offset:0
ds_read_b64_tr_b16 v[16:17], v2 offset:0
ds_read_b64_tr_b16 v[18:19], v2 offset:4608
ds_read_b128 v[40:43], v6 offset:2048
ds_read_b64_tr_b16 v[20:21], v2 offset:32
ds_read_b64_tr_b16 v[22:23], v2 offset:4640
ds_read_b64_tr_b16 v[24:25], v2 offset:64
ds_read_b64_tr_b16 v[26:27], v2 offset:4672
ds_read_b64_tr_b16 v[28:29], v2 offset:96
ds_read_b64_tr_b16 v[30:31], v2 offset:4704
ds_read_b128 v[44:47], v10 offset:0
ds_read_b64_tr_b16 v[32:33], v124 offset:0
ds_read_b64_tr_b16 v[34:35], v124 offset:4608
L_BODY:
s_waitcnt lgkmcnt(9)
v_mfma_f32_16x16x32_bf16 v[80:83], v[16:19], v[36:39], v[80:83]
ds_read_b128 v[68:71], v7 offset:0
ds_read_b64_tr_b16 v[48:49], v2 offset:9216
v_mfma_f32_16x16x32_bf16 v[96:99], v[16:19], v[40:43], v[96:99]
ds_read_b64_tr_b16 v[50:51], v2 offset:13824
s_waitcnt lgkmcnt(10)
v_mfma_f32_16x16x32_bf16 v[84:87], v[20:23], v[36:39], v[84:87]
ds_read_b128 v[72:75], v7 offset:2048
ds_read_b64_tr_b16 v[52:53], v2 offset:9248
v_mfma_f32_16x16x32_bf16 v[100:103], v[20:23], v[40:43], v[100:103]
ds_read_b64_tr_b16 v[54:55], v2 offset:13856
s_waitcnt lgkmcnt(11)
v_mfma_f32_16x16x32_bf16 v[88:91], v[24:27], v[36:39], v[88:91]
ds_read_b64_tr_b16 v[56:57], v2 offset:9280
ds_read_b64_tr_b16 v[58:59], v2 offset:13888
v_mfma_f32_16x16x32_bf16 v[104:107], v[24:27], v[40:43], v[104:107]
ds_read_b64_tr_b16 v[60:61], v2 offset:9312
s_waitcnt lgkmcnt(12)
v_mfma_f32_16x16x32_bf16 v[92:95], v[28:31], v[36:39], v[92:95]
ds_read_b64_tr_b16 v[62:63], v2 offset:13920
ds_read_b128 v[76:79], v11 offset:0
v_mfma_f32_16x16x32_bf16 v[108:111], v[28:31], v[40:43], v[108:111]
ds_read_b64_tr_b16 v[64:65], v124 offset:9216
s_waitcnt lgkmcnt(12)
v_mfma_f32_16x16x32_bf16 v[112:115], v[32:35], v[44:47], v[112:115]
ds_read_b64_tr_b16 v[66:67], v124 offset:13824
s_barrier
s_waitcnt lgkmcnt(9)
v_mfma_f32_16x16x32_bf16 v[80:83], v[48:51], v[68:71], v[80:83]
ds_read_b128 v[36:39], v6 offset:4096
ds_read_b64_tr_b16 v[16:17], v2 offset:18432
v_mfma_f32_16x16x32_bf16 v[96:99], v[48:51], v[72:75], v[96:99]
ds_read_b64_tr_b16 v[18:19], v2 offset:23040
s_waitcnt lgkmcnt(10)
v_mfma_f32_16x16x32_bf16 v[84:87], v[52:55], v[68:71], v[84:87]
ds_read_b128 v[40:43], v6 offset:6144
ds_read_b64_tr_b16 v[20:21], v2 offset:18464
v_mfma_f32_16x16x32_bf16 v[100:103], v[52:55], v[72:75], v[100:103]
ds_read_b64_tr_b16 v[22:23], v2 offset:23072
s_waitcnt lgkmcnt(11)
v_mfma_f32_16x16x32_bf16 v[88:91], v[56:59], v[68:71], v[88:91]
ds_read_b64_tr_b16 v[24:25], v2 offset:18496
ds_read_b64_tr_b16 v[26:27], v2 offset:23104
v_mfma_f32_16x16x32_bf16 v[104:107], v[56:59], v[72:75], v[104:107]
ds_read_b64_tr_b16 v[28:29], v2 offset:18528
s_waitcnt lgkmcnt(12)
v_mfma_f32_16x16x32_bf16 v[92:95], v[60:63], v[68:71], v[92:95]
ds_read_b64_tr_b16 v[30:31], v2 offset:23136
ds_read_b128 v[44:47], v10 offset:4096
v_mfma_f32_16x16x32_bf16 v[108:111], v[60:63], v[72:75], v[108:111]
ds_read_b64_tr_b16 v[32:33], v124 offset:18432
s_waitcnt lgkmcnt(12)
v_mfma_f32_16x16x32_bf16 v[112:115], v[64:67], v[76:79], v[112:115]
ds_read_b64_tr_b16 v[34:35], v124 offset:23040
s_waitcnt lgkmcnt(9)
v_mfma_f32_16x16x32_bf16 v[80:83], v[16:19], v[36:39], v[80:83]
ds_read_b128 v[68:71], v7 offset:4096
ds_read_b64_tr_b16 v[48:49], v2 offset:27648
v_mfma_f32_16x16x32_bf16 v[96:99], v[16:19], v[40:43], v[96:99]
ds_read_b64_tr_b16 v[50:51], v2 offset:32256
s_waitcnt lgkmcnt(10)
v_mfma_f32_16x16x32_bf16 v[84:87], v[20:23], v[36:39], v[84:87]
ds_read_b128 v[72:75], v7 offset:6144
ds_read_b64_tr_b16 v[52:53], v2 offset:27680
v_mfma_f32_16x16x32_bf16 v[100:103], v[20:23], v[40:43], v[100:103]
ds_read_b64_tr_b16 v[54:55], v2 offset:32288
s_waitcnt lgkmcnt(11)
v_mfma_f32_16x16x32_bf16 v[88:91], v[24:27], v[36:39], v[88:91]
ds_read_b64_tr_b16 v[56:57], v2 offset:27712
ds_read_b64_tr_b16 v[58:59], v2 offset:32320
v_mfma_f32_16x16x32_bf16 v[104:107], v[24:27], v[40:43], v[104:107]
ds_read_b64_tr_b16 v[60:61], v2 offset:27744
s_waitcnt lgkmcnt(12)
v_mfma_f32_16x16x32_bf16 v[92:95], v[28:31], v[36:39], v[92:95]
ds_read_b64_tr_b16 v[62:63], v2 offset:32352
ds_read_b128 v[76:79], v11 offset:4096
v_mfma_f32_16x16x32_bf16 v[108:111], v[28:31], v[40:43], v[108:111]
ds_read_b64_tr_b16 v[64:65], v124 offset:27648
s_waitcnt lgkmcnt(12)
v_mfma_f32_16x16x32_bf16 v[112:115], v[32:35], v[44:47], v[112:115]
ds_read_b64_tr_b16 v[66:67], v124 offset:32256
s_cmp_eq_u32 s2, 0
s_cbranch_scc0 L_NW0
s_waitcnt vmcnt(0)
L_NW0:
s_barrier
s_lshl_b32 s37, s2, 2
s_or_b32 s37, s37, s32
s_cmp_eq_u32 s37, 0
s_cbranch_scc0 L_PUB0
v_mov_b32 v12, 1
s_mov_b64 exec, 1
buffer_store_dword v12, off, s[44:47], 0 sc1
s_mov_b64 exec, -1
L_PUB0:
s_waitcnt lgkmcnt(9)
v_mfma_f32_16x16x32_bf16 v[80:83], v[48:51], v[68:71], v[80:83]
ds_read_b128 v[36:39], v6 offset:8192
ds_read_b64_tr_b16 v[16:17], v3 offset:0
v_mfma_f32_16x16x32_bf16 v[96:99], v[48:51], v[72:75], v[96:99]
ds_read_b64_tr_b16 v[18:19], v3 offset:4608
s_waitcnt lgkmcnt(10)
v_mfma_f32_16x16x32_bf16 v[84:87], v[52:55], v[68:71], v[84:87]
ds_read_b128 v[40:43], v6 offset:10240
ds_read_b64_tr_b16 v[20:21], v3 offset:32
v_mfma_f32_16x16x32_bf16 v[100:103], v[52:55], v[72:75], v[100:103]
ds_read_b64_tr_b16 v[22:23], v3 offset:4640
s_waitcnt lgkmcnt(11)
v_mfma_f32_16x16x32_bf16 v[88:91], v[56:59], v[68:71], v[88:91]
ds_read_b64_tr_b16 v[24:25], v3 offset:64
ds_read_b64_tr_b16 v[26:27], v3 offset:4672
v_mfma_f32_16x16x32_bf16 v[104:107], v[56:59], v[72:75], v[104:107]
ds_read_b64_tr_b16 v[28:29], v3 offset:96
s_waitcnt lgkmcnt(12)
v_mfma_f32_16x16x32_bf16 v[92:95], v[60:63], v[68:71], v[92:95]
ds_read_b64_tr_b16 v[30:31], v3 offset:4704
ds_read_b128 v[44:47], v10 offset:8192
v_mfma_f32_16x16x32_bf16 v[108:111], v[60:63], v[72:75], v[108:111]
ds_read_b64_tr_b16 v[32:33], v125 offset:0
s_waitcnt lgkmcnt(12)
v_mfma_f32_16x16x32_bf16 v[112:115], v[64:67], v[76:79], v[112:115]
ds_read_b64_tr_b16 v[34:35], v125 offset:4608
s_waitcnt lgkmcnt(9)
v_mfma_f32_16x16x32_bf16 v[80:83], v[16:19], v[36:39], v[80:83]
ds_read_b128 v[68:71], v7 offset:8192
ds_read_b64_tr_b16 v[48:49], v3 offset:9216
v_mfma_f32_16x16x32_bf16 v[96:99], v[16:19], v[40:43], v[96:99]
ds_read_b64_tr_b16 v[50:51], v3 offset:13824
s_waitcnt lgkmcnt(10)
v_mfma_f32_16x16x32_bf16 v[84:87], v[20:23], v[36:39], v[84:87]
ds_read_b128 v[72:75], v7 offset:10240
ds_read_b64_tr_b16 v[52:53], v3 offset:9248
v_mfma_f32_16x16x32_bf16 v[100:103], v[20:23], v[40:43], v[100:103]
ds_read_b64_tr_b16 v[54:55], v3 offset:13856
s_waitcnt lgkmcnt(11)
v_mfma_f32_16x16x32_bf16 v[88:91], v[24:27], v[36:39], v[88:91]
ds_read_b64_tr_b16 v[56:57], v3 offset:9280
ds_read_b64_tr_b16 v[58:59], v3 offset:13888
v_mfma_f32_16x16x32_bf16 v[104:107], v[24:27], v[40:43], v[104:107]
ds_read_b64_tr_b16 v[60:61], v3 offset:9312
s_waitcnt lgkmcnt(12)
v_mfma_f32_16x16x32_bf16 v[92:95], v[28:31], v[36:39], v[92:95]
ds_read_b64_tr_b16 v[62:63], v3 offset:13920
ds_read_b128 v[76:79], v11 offset:8192
v_mfma_f32_16x16x32_bf16 v[108:111], v[28:31], v[40:43], v[108:111]
ds_read_b64_tr_b16 v[64:65], v125 offset:9216
s_waitcnt lgkmcnt(12)
v_mfma_f32_16x16x32_bf16 v[112:115], v[32:35], v[44:47], v[112:115]
ds_read_b64_tr_b16 v[66:67], v125 offset:13824
s_barrier
s_waitcnt lgkmcnt(9)
v_mfma_f32_16x16x32_bf16 v[80:83], v[48:51], v[68:71], v[80:83]
ds_read_b128 v[36:39], v6 offset:12288
ds_read_b64_tr_b16 v[16:17], v3 offset:18432
v_mfma_f32_16x16x32_bf16 v[96:99], v[48:51], v[72:75], v[96:99]
ds_read_b64_tr_b16 v[18:19], v3 offset:23040
s_waitcnt lgkmcnt(10)
v_mfma_f32_16x16x32_bf16 v[84:87], v[52:55], v[68:71], v[84:87]
ds_read_b128 v[40:43], v6 offset:14336
ds_read_b64_tr_b16 v[20:21], v3 offset:18464
v_mfma_f32_16x16x32_bf16 v[100:103], v[52:55], v[72:75], v[100:103]
ds_read_b64_tr_b16 v[22:23], v3 offset:23072
s_waitcnt lgkmcnt(11)
v_mfma_f32_16x16x32_bf16 v[88:91], v[56:59], v[68:71], v[88:91]
ds_read_b64_tr_b16 v[24:25], v3 offset:18496
ds_read_b64_tr_b16 v[26:27], v3 offset:23104
v_mfma_f32_16x16x32_bf16 v[104:107], v[56:59], v[72:75], v[104:107]
ds_read_b64_tr_b16 v[28:29], v3 offset:18528
s_waitcnt lgkmcnt(12)
v_mfma_f32_16x16x32_bf16 v[92:95], v[60:63], v[68:71], v[92:95]
ds_read_b64_tr_b16 v[30:31], v3 offset:23136
ds_read_b128 v[44:47], v10 offset:12288
v_mfma_f32_16x16x32_bf16 v[108:111], v[60:63], v[72:75], v[108:111]
ds_read_b64_tr_b16 v[32:33], v125 offset:18432
s_waitcnt lgkmcnt(12)
v_mfma_f32_16x16x32_bf16 v[112:115], v[64:67], v[76:79], v[112:115]
ds_read_b64_tr_b16 v[34:35], v125 offset:23040
s_waitcnt lgkmcnt(9)
v_mfma_f32_16x16x32_bf16 v[80:83], v[16:19], v[36:39], v[80:83]
ds_read_b128 v[68:71], v7 offset:12288
ds_read_b64_tr_b16 v[48:49], v3 offset:27648
v_mfma_f32_16x16x32_bf16 v[96:99], v[16:19], v[40:43], v[96:99]
ds_read_b64_tr_b16 v[50:51], v3 offset:32256
s_waitcnt lgkmcnt(10)
v_mfma_f32_16x16x32_bf16 v[84:87], v[20:23], v[36:39], v[84:87]
ds_read_b128 v[72:75], v7 offset:14336
ds_read_b64_tr_b16 v[52:53], v3 offset:27680
v_mfma_f32_16x16x32_bf16 v[100:103], v[20:23], v[40:43], v[100:103]
ds_read_b64_tr_b16 v[54:55], v3 offset:32288
s_waitcnt lgkmcnt(11)
v_mfma_f32_16x16x32_bf16 v[88:91], v[24:27], v[36:39], v[88:91]
ds_read_b64_tr_b16 v[56:57], v3 offset:27712
ds_read_b64_tr_b16 v[58:59], v3 offset:32320
v_mfma_f32_16x16x32_bf16 v[104:107], v[24:27], v[40:43], v[104:107]
ds_read_b64_tr_b16 v[60:61], v3 offset:27744
s_waitcnt lgkmcnt(12)
v_mfma_f32_16x16x32_bf16 v[92:95], v[28:31], v[36:39], v[92:95]
ds_read_b64_tr_b16 v[62:63], v3 offset:32352
ds_read_b128 v[76:79], v11 offset:12288
v_mfma_f32_16x16x32_bf16 v[108:111], v[28:31], v[40:43], v[108:111]
ds_read_b64_tr_b16 v[64:65], v125 offset:27648
s_waitcnt lgkmcnt(12)
v_mfma_f32_16x16x32_bf16 v[112:115], v[32:35], v[44:47], v[112:115]
ds_read_b64_tr_b16 v[66:67], v125 offset:32256
s_barrier
s_waitcnt lgkmcnt(9)
v_mfma_f32_16x16x32_bf16 v[80:83], v[48:51], v[68:71], v[80:83]
ds_read_b128 v[36:39], v6 offset:16384
ds_read_b64_tr_b16 v[16:17], v4 offset:0
v_mfma_f32_16x16x32_bf16 v[96:99], v[48:51], v[72:75], v[96:99]
ds_read_b64_tr_b16 v[18:19], v4 offset:4608
s_waitcnt lgkmcnt(10)
v_mfma_f32_16x16x32_bf16 v[84:87], v[52:55], v[68:71], v[84:87]
ds_read_b128 v[40:43], v6 offset:18432
ds_read_b64_tr_b16 v[20:21], v4 offset:32
v_mfma_f32_16x16x32_bf16 v[100:103], v[52:55], v[72:75], v[100:103]
ds_read_b64_tr_b16 v[22:23], v4 offset:4640
s_waitcnt lgkmcnt(11)
v_mfma_f32_16x16x32_bf16 v[88:91], v[56:59], v[68:71], v[88:91]
ds_read_b64_tr_b16 v[24:25], v4 offset:64
ds_read_b64_tr_b16 v[26:27], v4 offset:4672
v_mfma_f32_16x16x32_bf16 v[104:107], v[56:59], v[72:75], v[104:107]
ds_read_b64_tr_b16 v[28:29], v4 offset:96
s_waitcnt lgkmcnt(12)
v_mfma_f32_16x16x32_bf16 v[92:95], v[60:63], v[68:71], v[92:95]
ds_read_b64_tr_b16 v[30:31], v4 offset:4704
ds_read_b128 v[44:47], v10 offset:16384
v_mfma_f32_16x16x32_bf16 v[108:111], v[60:63], v[72:75], v[108:111]
ds_read_b64_tr_b16 v[32:33], v126 offset:0
s_waitcnt lgkmcnt(12)
v_mfma_f32_16x16x32_bf16 v[112:115], v[64:67], v[76:79], v[112:115]
ds_read_b64_tr_b16 v[34:35], v126 offset:4608
s_waitcnt lgkmcnt(9)
v_mfma_f32_16x16x32_bf16 v[80:83], v[16:19], v[36:39], v[80:83]
ds_read_b128 v[68:71], v7 offset:16384
ds_read_b64_tr_b16 v[48:49], v4 offset:9216
v_mfma_f32_16x16x32_bf16 v[96:99], v[16:19], v[40:43], v[96:99]
ds_read_b64_tr_b16 v[50:51], v4 offset:13824
s_waitcnt lgkmcnt(10)
v_mfma_f32_16x16x32_bf16 v[84:87], v[20:23], v[36:39], v[84:87]
ds_read_b128 v[72:75], v7 offset:18432
ds_read_b64_tr_b16 v[52:53], v4 offset:9248
v_mfma_f32_16x16x32_bf16 v[100:103], v[20:23], v[40:43], v[100:103]
ds_read_b64_tr_b16 v[54:55], v4 offset:13856
s_waitcnt lgkmcnt(11)
v_mfma_f32_16x16x32_bf16 v[88:91], v[24:27], v[36:39], v[88:91]
ds_read_b64_tr_b16 v[56:57], v4 offset:9280
ds_read_b64_tr_b16 v[58:59], v4 offset:13888
v_mfma_f32_16x16x32_bf16 v[104:107], v[24:27], v[40:43], v[104:107]
ds_read_b64_tr_b16 v[60:61], v4 offset:9312
s_waitcnt lgkmcnt(12)
v_mfma_f32_16x16x32_bf16 v[92:95], v[28:31], v[36:39], v[92:95]
ds_read_b64_tr_b16 v[62:63], v4 offset:13920
ds_read_b128 v[76:79], v11 offset:16384
v_mfma_f32_16x16x32_bf16 v[108:111], v[28:31], v[40:43], v[108:111]
ds_read_b64_tr_b16 v[64:65], v126 offset:9216
s_waitcnt lgkmcnt(12)
v_mfma_f32_16x16x32_bf16 v[112:115], v[32:35], v[44:47], v[112:115]
ds_read_b64_tr_b16 v[66:67], v126 offset:13824
s_barrier
s_waitcnt lgkmcnt(9)
v_mfma_f32_16x16x32_bf16 v[80:83], v[48:51], v[68:71], v[80:83]
ds_read_b128 v[36:39], v6 offset:0
ds_read_b64_tr_b16 v[16:17], v4 offset:18432
v_mfma_f32_16x16x32_bf16 v[96:99], v[48:51], v[72:75], v[96:99]
ds_read_b64_tr_b16 v[18:19], v4 offset:23040
s_waitcnt lgkmcnt(10)
v_mfma_f32_16x16x32_bf16 v[84:87], v[52:55], v[68:71], v[84:87]
ds_read_b128 v[40:43], v6 offset:2048
ds_read_b64_tr_b16 v[20:21], v4 offset:18464
v_mfma_f32_16x16x32_bf16 v[100:103], v[52:55], v[72:75], v[100:103]
ds_read_b64_tr_b16 v[22:23], v4 offset:23072
s_waitcnt lgkmcnt(11)
v_mfma_f32_16x16x32_bf16 v[88:91], v[56:59], v[68:71], v[88:91]
ds_read_b64_tr_b16 v[24:25], v4 offset:18496
ds_read_b64_tr_b16 v[26:27], v4 offset:23104
v_mfma_f32_16x16x32_bf16 v[104:107], v[56:59], v[72:75], v[104:107]
ds_read_b64_tr_b16 v[28:29], v4 offset:18528
s_waitcnt lgkmcnt(12)
v_mfma_f32_16x16x32_bf16 v[92:95], v[60:63], v[68:71], v[92:95]
ds_read_b64_tr_b16 v[30:31], v4 offset:23136
ds_read_b128 v[44:47], v10 offset:0
v_mfma_f32_16x16x32_bf16 v[108:111], v[60:63], v[72:75], v[108:111]
ds_read_b64_tr_b16 v[32:33], v126 offset:18432
s_waitcnt lgkmcnt(12)
v_mfma_f32_16x16x32_bf16 v[112:115], v[64:67], v[76:79], v[112:115]
ds_read_b64_tr_b16 v[34:35], v126 offset:23040
s_waitcnt lgkmcnt(9)
v_mfma_f32_16x16x32_bf16 v[80:83], v[16:19], v[36:39], v[80:83]
ds_read_b128 v[68:71], v7 offset:0
ds_read_b64_tr_b16 v[48:49], v4 offset:27648
v_mfma_f32_16x16x32_bf16 v[96:99], v[16:19], v[40:43], v[96:99]
ds_read_b64_tr_b16 v[50:51], v4 offset:32256
s_waitcnt lgkmcnt(10)
v_mfma_f32_16x16x32_bf16 v[84:87], v[20:23], v[36:39], v[84:87]
ds_read_b128 v[72:75], v7 offset:2048
ds_read_b64_tr_b16 v[52:53], v4 offset:27680
v_mfma_f32_16x16x32_bf16 v[100:103], v[20:23], v[40:43], v[100:103]
ds_read_b64_tr_b16 v[54:55], v4 offset:32288
s_waitcnt lgkmcnt(11)
v_mfma_f32_16x16x32_bf16 v[88:91], v[24:27], v[36:39], v[88:91]
ds_read_b64_tr_b16 v[56:57], v4 offset:27712
ds_read_b64_tr_b16 v[58:59], v4 offset:32320
v_mfma_f32_16x16x32_bf16 v[104:107], v[24:27], v[40:43], v[104:107]
ds_read_b64_tr_b16 v[60:61], v4 offset:27744
s_waitcnt lgkmcnt(12)
v_mfma_f32_16x16x32_bf16 v[92:95], v[28:31], v[36:39], v[92:95]
ds_read_b64_tr_b16 v[62:63], v4 offset:32352
ds_read_b128 v[76:79], v11 offset:0
v_mfma_f32_16x16x32_bf16 v[108:111], v[28:31], v[40:43], v[108:111]
ds_read_b64_tr_b16 v[64:65], v126 offset:27648
s_waitcnt lgkmcnt(12)
v_mfma_f32_16x16x32_bf16 v[112:115], v[32:35], v[44:47], v[112:115]
ds_read_b64_tr_b16 v[66:67], v126 offset:32256
s_barrier
s_waitcnt lgkmcnt(9)
v_mfma_f32_16x16x32_bf16 v[80:83], v[48:51], v[68:71], v[80:83]
ds_read_b128 v[36:39], v6 offset:4096
ds_read_b64_tr_b16 v[16:17], v2 offset:0
v_mfma_f32_16x16x32_bf16 v[96:99], v[48:51], v[72:75], v[96:99]
ds_read_b64_tr_b16 v[18:19], v2 offset:4608
s_waitcnt lgkmcnt(10)
v_mfma_f32_16x16x32_bf16 v[84:87], v[52:55], v[68:71], v[84:87]
ds_read_b128 v[40:43], v6 offset:6144
ds_read_b64_tr_b16 v[20:21], v2 offset:32
v_mfma_f32_16x16x32_bf16 v[100:103], v[52:55], v[72:75], v[100:103]
ds_read_b64_tr_b16 v[22:23], v2 offset:4640
s_waitcnt lgkmcnt(11)
v_mfma_f32_16x16x32_bf16 v[88:91], v[56:59], v[68:71], v[88:91]
ds_read_b64_tr_b16 v[24:25], v2 offset:64
ds_read_b64_tr_b16 v[26:27], v2 offset:4672
v_mfma_f32_16x16x32_bf16 v[104:107], v[56:59], v[72:75], v[104:107]
ds_read_b64_tr_b16 v[28:29], v2 offset:96
s_waitcnt lgkmcnt(12)
v_mfma_f32_16x16x32_bf16 v[92:95], v[60:63], v[68:71], v[92:95]
ds_read_b64_tr_b16 v[30:31], v2 offset:4704
ds_read_b128 v[44:47], v10 offset:4096
v_mfma_f32_16x16x32_bf16 v[108:111], v[60:63], v[72:75], v[108:111]
ds_read_b64_tr_b16 v[32:33], v124 offset:0
s_waitcnt lgkmcnt(12)
v_mfma_f32_16x16x32_bf16 v[112:115], v[64:67], v[76:79], v[112:115]
ds_read_b64_tr_b16 v[34:35], v124 offset:4608
s_waitcnt lgkmcnt(9)
v_mfma_f32_16x16x32_bf16 v[80:83], v[16:19], v[36:39], v[80:83]
ds_read_b128 v[68:71], v7 offset:4096
ds_read_b64_tr_b16 v[48:49], v2 offset:9216
v_mfma_f32_16x16x32_bf16 v[96:99], v[16:19], v[40:43], v[96:99]
ds_read_b64_tr_b16 v[50:51], v2 offset:13824
s_waitcnt lgkmcnt(10)
v_mfma_f32_16x16x32_bf16 v[84:87], v[20:23], v[36:39], v[84:87]
ds_read_b128 v[72:75], v7 offset:6144
ds_read_b64_tr_b16 v[52:53], v2 offset:9248
v_mfma_f32_16x16x32_bf16 v[100:103], v[20:23], v[40:43], v[100:103]
ds_read_b64_tr_b16 v[54:55], v2 offset:13856
s_waitcnt lgkmcnt(11)
v_mfma_f32_16x16x32_bf16 v[88:91], v[24:27], v[36:39], v[88:91]
ds_read_b64_tr_b16 v[56:57], v2 offset:9280
ds_read_b64_tr_b16 v[58:59], v2 offset:13888
v_mfma_f32_16x16x32_bf16 v[104:107], v[24:27], v[40:43], v[104:107]
ds_read_b64_tr_b16 v[60:61], v2 offset:9312
s_waitcnt lgkmcnt(12)
v_mfma_f32_16x16x32_bf16 v[92:95], v[28:31], v[36:39], v[92:95]
ds_read_b64_tr_b16 v[62:63], v2 offset:13920
ds_read_b128 v[76:79], v11 offset:4096
v_mfma_f32_16x16x32_bf16 v[108:111], v[28:31], v[40:43], v[108:111]
ds_read_b64_tr_b16 v[64:65], v124 offset:9216
s_waitcnt lgkmcnt(12)
v_mfma_f32_16x16x32_bf16 v[112:115], v[32:35], v[44:47], v[112:115]
ds_read_b64_tr_b16 v[66:67], v124 offset:13824
s_barrier
s_waitcnt lgkmcnt(9)
v_mfma_f32_16x16x32_bf16 v[80:83], v[48:51], v[68:71], v[80:83]
ds_read_b128 v[36:39], v6 offset:8192
ds_read_b64_tr_b16 v[16:17], v2 offset:18432
v_mfma_f32_16x16x32_bf16 v[96:99], v[48:51], v[72:75], v[96:99]
ds_read_b64_tr_b16 v[18:19], v2 offset:23040
s_waitcnt lgkmcnt(10)
v_mfma_f32_16x16x32_bf16 v[84:87], v[52:55], v[68:71], v[84:87]
ds_read_b128 v[40:43], v6 offset:10240
ds_read_b64_tr_b16 v[20:21], v2 offset:18464
v_mfma_f32_16x16x32_bf16 v[100:103], v[52:55], v[72:75], v[100:103]
ds_read_b64_tr_b16 v[22:23], v2 offset:23072
s_waitcnt lgkmcnt(11)
v_mfma_f32_16x16x32_bf16 v[88:91], v[56:59], v[68:71], v[88:91]
ds_read_b64_tr_b16 v[24:25], v2 offset:18496
ds_read_b64_tr_b16 v[26:27], v2 offset:23104
v_mfma_f32_16x16x32_bf16 v[104:107], v[56:59], v[72:75], v[104:107]
ds_read_b64_tr_b16 v[28:29], v2 offset:18528
s_waitcnt lgkmcnt(12)
v_mfma_f32_16x16x32_bf16 v[92:95], v[60:63], v[68:71], v[92:95]
ds_read_b64_tr_b16 v[30:31], v2 offset:23136
ds_read_b128 v[44:47], v10 offset:8192
v_mfma_f32_16x16x32_bf16 v[108:111], v[60:63], v[72:75], v[108:111]
ds_read_b64_tr_b16 v[32:33], v124 offset:18432
s_waitcnt lgkmcnt(12)
v_mfma_f32_16x16x32_bf16 v[112:115], v[64:67], v[76:79], v[112:115]
ds_read_b64_tr_b16 v[34:35], v124 offset:23040
s_waitcnt lgkmcnt(9)
v_mfma_f32_16x16x32_bf16 v[80:83], v[16:19], v[36:39], v[80:83]
ds_read_b128 v[68:71], v7 offset:8192
ds_read_b64_tr_b16 v[48:49], v2 offset:27648
v_mfma_f32_16x16x32_bf16 v[96:99], v[16:19], v[40:43], v[96:99]
ds_read_b64_tr_b16 v[50:51], v2 offset:32256
s_waitcnt lgkmcnt(10)
v_mfma_f32_16x16x32_bf16 v[84:87], v[20:23], v[36:39], v[84:87]
ds_read_b128 v[72:75], v7 offset:10240
ds_read_b64_tr_b16 v[52:53], v2 offset:27680
v_mfma_f32_16x16x32_bf16 v[100:103], v[20:23], v[40:43], v[100:103]
ds_read_b64_tr_b16 v[54:55], v2 offset:32288
s_waitcnt lgkmcnt(11)
v_mfma_f32_16x16x32_bf16 v[88:91], v[24:27], v[36:39], v[88:91]
ds_read_b64_tr_b16 v[56:57], v2 offset:27712
ds_read_b64_tr_b16 v[58:59], v2 offset:32320
v_mfma_f32_16x16x32_bf16 v[104:107], v[24:27], v[40:43], v[104:107]
ds_read_b64_tr_b16 v[60:61], v2 offset:27744
s_waitcnt lgkmcnt(12)
v_mfma_f32_16x16x32_bf16 v[92:95], v[28:31], v[36:39], v[92:95]
ds_read_b64_tr_b16 v[62:63], v2 offset:32352
ds_read_b128 v[76:79], v11 offset:8192
v_mfma_f32_16x16x32_bf16 v[108:111], v[28:31], v[40:43], v[108:111]
ds_read_b64_tr_b16 v[64:65], v124 offset:27648
s_waitcnt lgkmcnt(12)
v_mfma_f32_16x16x32_bf16 v[112:115], v[32:35], v[44:47], v[112:115]
ds_read_b64_tr_b16 v[66:67], v124 offset:32256
s_barrier
s_waitcnt lgkmcnt(9)
v_mfma_f32_16x16x32_bf16 v[80:83], v[48:51], v[68:71], v[80:83]
ds_read_b128 v[36:39], v6 offset:12288
ds_read_b64_tr_b16 v[16:17], v3 offset:0
v_mfma_f32_16x16x32_bf16 v[96:99], v[48:51], v[72:75], v[96:99]
ds_read_b64_tr_b16 v[18:19], v3 offset:4608
s_waitcnt lgkmcnt(10)
v_mfma_f32_16x16x32_bf16 v[84:87], v[52:55], v[68:71], v[84:87]
ds_read_b128 v[40:43], v6 offset:14336
ds_read_b64_tr_b16 v[20:21], v3 offset:32
v_mfma_f32_16x16x32_bf16 v[100:103], v[52:55], v[72:75], v[100:103]
ds_read_b64_tr_b16 v[22:23], v3 offset:4640
s_waitcnt lgkmcnt(11)
v_mfma_f32_16x16x32_bf16 v[88:91], v[56:59], v[68:71], v[88:91]
ds_read_b64_tr_b16 v[24:25], v3 offset:64
ds_read_b64_tr_b16 v[26:27], v3 offset:4672
v_mfma_f32_16x16x32_bf16 v[104:107], v[56:59], v[72:75], v[104:107]
ds_read_b64_tr_b16 v[28:29], v3 offset:96
s_waitcnt lgkmcnt(12)
v_mfma_f32_16x16x32_bf16 v[92:95], v[60:63], v[68:71], v[92:95]
ds_read_b64_tr_b16 v[30:31], v3 offset:4704
ds_read_b128 v[44:47], v10 offset:12288
v_mfma_f32_16x16x32_bf16 v[108:111], v[60:63], v[72:75], v[108:111]
ds_read_b64_tr_b16 v[32:33], v125 offset:0
s_waitcnt lgkmcnt(12)
v_mfma_f32_16x16x32_bf16 v[112:115], v[64:67], v[76:79], v[112:115]
ds_read_b64_tr_b16 v[34:35], v125 offset:4608
s_waitcnt lgkmcnt(9)
v_mfma_f32_16x16x32_bf16 v[80:83], v[16:19], v[36:39], v[80:83]
ds_read_b128 v[68:71], v7 offset:12288
ds_read_b64_tr_b16 v[48:49], v3 offset:9216
v_mfma_f32_16x16x32_bf16 v[96:99], v[16:19], v[40:43], v[96:99]
ds_read_b64_tr_b16 v[50:51], v3 offset:13824
s_waitcnt lgkmcnt(10)
v_mfma_f32_16x16x32_bf16 v[84:87], v[20:23], v[36:39], v[84:87]
ds_read_b128 v[72:75], v7 offset:14336
ds_read_b64_tr_b16 v[52:53], v3 offset:9248
v_mfma_f32_16x16x32_bf16 v[100:103], v[20:23], v[40:43], v[100:103]
ds_read_b64_tr_b16 v[54:55], v3 offset:13856
s_waitcnt lgkmcnt(11)
v_mfma_f32_16x16x32_bf16 v[88:91], v[24:27], v[36:39], v[88:91]
ds_read_b64_tr_b16 v[56:57], v3 offset:9280
ds_read_b64_tr_b16 v[58:59], v3 offset:13888
v_mfma_f32_16x16x32_bf16 v[104:107], v[24:27], v[40:43], v[104:107]
ds_read_b64_tr_b16 v[60:61], v3 offset:9312
s_waitcnt lgkmcnt(12)
v_mfma_f32_16x16x32_bf16 v[92:95], v[28:31], v[36:39], v[92:95]
ds_read_b64_tr_b16 v[62:63], v3 offset:13920
ds_read_b128 v[76:79], v11 offset:12288
v_mfma_f32_16x16x32_bf16 v[108:111], v[28:31], v[40:43], v[108:111]
ds_read_b64_tr_b16 v[64:65], v125 offset:9216
s_waitcnt lgkmcnt(12)
v_mfma_f32_16x16x32_bf16 v[112:115], v[32:35], v[44:47], v[112:115]
ds_read_b64_tr_b16 v[66:67], v125 offset:13824
s_waitcnt lgkmcnt(9)
v_mfma_f32_16x16x32_bf16 v[80:83], v[48:51], v[68:71], v[80:83]
v_mfma_f32_16x16x32_bf16 v[96:99], v[48:51], v[72:75], v[96:99]
s_waitcnt lgkmcnt(7)
v_mfma_f32_16x16x32_bf16 v[84:87], v[52:55], v[68:71], v[84:87]
v_mfma_f32_16x16x32_bf16 v[100:103], v[52:55], v[72:75], v[100:103]
s_waitcnt lgkmcnt(5)
v_mfma_f32_16x16x32_bf16 v[88:91], v[56:59], v[68:71], v[88:91]
v_mfma_f32_16x16x32_bf16 v[104:107], v[56:59], v[72:75], v[104:107]
s_waitcnt lgkmcnt(3)
v_mfma_f32_16x16x32_bf16 v[92:95], v[60:63], v[68:71], v[92:95]
v_mfma_f32_16x16x32_bf16 v[108:111], v[60:63], v[72:75], v[108:111]
s_waitcnt lgkmcnt(0)
v_mfma_f32_16x16x32_bf16 v[112:115], v[64:67], v[76:79], v[112:115]
s_barrier
s_waitcnt vmcnt(0)
buffer_load_dword v12, off, s[44:47], 0 sc1
v_lshlrev_b32 v13, 4, v0
s_lshr_b32 s36, s32, 1
s_mul_i32 s36, s36, 20480
s_add_u32 s36, s36, 110592
s_and_b32 s37, s32, 1
s_lshl_b32 s38, s37, 12
s_add_u32 s38, s38, s36
v_add_u32 v14, s38, v13
v_pk_mul_f32 v[116:117], v[112:113], s[84:85]
v_pk_mul_f32 v[118:119], v[114:115], s[84:85]
v_exp_f32 v116, v116
v_exp_f32 v117, v117
v_exp_f32 v118, v118
v_exp_f32 v119, v119
v_pk_add_f32 v[116:117], v[116:117], 1.0 op_sel_hi:[1,0]
v_pk_add_f32 v[118:119], v[118:119], 1.0 op_sel_hi:[1,0]
v_rcp_f32 v116, v116
v_rcp_f32 v117, v117
v_rcp_f32 v118, v118
v_rcp_f32 v119, v119
v_pk_mul_f32 v[112:113], v[112:113], v[116:117]
v_pk_mul_f32 v[114:115], v[114:115], v[118:119]
v_cvt_pk_bf16_f32 v32, v112, v113
v_cvt_pk_bf16_f32 v33, v114, v115
v_mov_b32 v34, v32
v_mov_b32 v35, v33
v_bfe_u32 v15, v0, 4, 1
v_lshlrev_b32 v15, 9, v15
v_and_b32 v120, 15, v0
v_lshl_add_u32 v15, v120, 4, v15
v_permlane32_swap_b32 v32, v34
v_permlane32_swap_b32 v33, v35
s_mov_b32 exec_hi, 0
buffer_store_dwordx4 v[32:35], v15, s[24:27], s50 offen sc1
s_mov_b32 exec_hi, -1
v_pk_mul_f32 v[116:117], v[80:81], s[84:85]
v_pk_mul_f32 v[118:119], v[82:83], s[84:85]
v_exp_f32 v116, v116
v_exp_f32 v117, v117
v_exp_f32 v118, v118
v_exp_f32 v119, v119
v_pk_add_f32 v[116:117], v[116:117], 1.0 op_sel_hi:[1,0]
v_pk_add_f32 v[118:119], v[118:119], 1.0 op_sel_hi:[1,0]
v_rcp_f32 v116, v116
v_rcp_f32 v117, v117
v_rcp_f32 v118, v118
v_rcp_f32 v119, v119
v_pk_mul_f32 v[80:81], v[80:81], v[116:117]
v_pk_mul_f32 v[82:83], v[82:83], v[118:119]
v_pk_mul_f32 v[120:121], v[96:97], s[84:85]
v_pk_mul_f32 v[122:123], v[98:99], s[84:85]
v_exp_f32 v120, v120
v_exp_f32 v121, v121
v_exp_f32 v122, v122
v_exp_f32 v123, v123
v_pk_add_f32 v[120:121], v[120:121], 1.0 op_sel_hi:[1,0]
v_pk_add_f32 v[122:123], v[122:123], 1.0 op_sel_hi:[1,0]
v_rcp_f32 v120, v120
v_rcp_f32 v121, v121
v_rcp_f32 v122, v122
v_rcp_f32 v123, v123
v_pk_mul_f32 v[96:97], v[96:97], v[120:121]
v_pk_mul_f32 v[98:99], v[98:99], v[122:123]
v_cvt_pk_bf16_f32 v16, v80, v81
v_cvt_pk_bf16_f32 v17, v82, v83
v_cvt_pk_bf16_f32 v18, v96, v97
v_cvt_pk_bf16_f32 v19, v98, v99
s_nop 1
v_permlane16_swap_b32 v16, v18
v_permlane16_swap_b32 v17, v19
s_nop 1
v_permlane32_swap_b32 v16, v18
v_permlane32_swap_b32 v17, v19
buffer_store_dwordx4 v[16:19], v13, s[24:27], s49 offen offset:0 sc1
ds_write_b128 v14, v[16:19] offset:0
v_pk_mul_f32 v[116:117], v[84:85], s[84:85]
v_pk_mul_f32 v[118:119], v[86:87], s[84:85]
v_exp_f32 v116, v116
v_exp_f32 v117, v117
v_exp_f32 v118, v118
v_exp_f32 v119, v119
v_pk_add_f32 v[116:117], v[116:117], 1.0 op_sel_hi:[1,0]
v_pk_add_f32 v[118:119], v[118:119], 1.0 op_sel_hi:[1,0]
v_rcp_f32 v116, v116
v_rcp_f32 v117, v117
v_rcp_f32 v118, v118
v_rcp_f32 v119, v119
v_pk_mul_f32 v[84:85], v[84:85], v[116:117]
v_pk_mul_f32 v[86:87], v[86:87], v[118:119]
v_pk_mul_f32 v[120:121], v[100:101], s[84:85]
v_pk_mul_f32 v[122:123], v[102:103], s[84:85]
v_exp_f32 v120, v120
v_exp_f32 v121, v121
v_exp_f32 v122, v122
v_exp_f32 v123, v123
v_pk_add_f32 v[120:121], v[120:121], 1.0 op_sel_hi:[1,0]
v_pk_add_f32 v[122:123], v[122:123], 1.0 op_sel_hi:[1,0]
v_rcp_f32 v120, v120
v_rcp_f32 v121, v121
v_rcp_f32 v122, v122
v_rcp_f32 v123, v123
v_pk_mul_f32 v[100:101], v[100:101], v[120:121]
v_pk_mul_f32 v[102:103], v[102:103], v[122:123]
v_cvt_pk_bf16_f32 v20, v84, v85
v_cvt_pk_bf16_f32 v21, v86, v87
v_cvt_pk_bf16_f32 v22, v100, v101
v_cvt_pk_bf16_f32 v23, v102, v103
s_nop 1
v_permlane16_swap_b32 v20, v22
v_permlane16_swap_b32 v21, v23
s_nop 1
v_permlane32_swap_b32 v20, v22
v_permlane32_swap_b32 v21, v23
buffer_store_dwordx4 v[20:23], v13, s[24:27], s49 offen offset:1024 sc1
ds_write_b128 v14, v[20:23] offset:1024
v_pk_mul_f32 v[116:117], v[88:89], s[84:85]
v_pk_mul_f32 v[118:119], v[90:91], s[84:85]
v_exp_f32 v116, v116
v_exp_f32 v117, v117
v_exp_f32 v118, v118
v_exp_f32 v119, v119
v_pk_add_f32 v[116:117], v[116:117], 1.0 op_sel_hi:[1,0]
v_pk_add_f32 v[118:119], v[118:119], 1.0 op_sel_hi:[1,0]
v_rcp_f32 v116, v116
v_rcp_f32 v117, v117
v_rcp_f32 v118, v118
v_rcp_f32 v119, v119
v_pk_mul_f32 v[88:89], v[88:89], v[116:117]
v_pk_mul_f32 v[90:91], v[90:91], v[118:119]
v_pk_mul_f32 v[120:121], v[104:105], s[84:85]
v_pk_mul_f32 v[122:123], v[106:107], s[84:85]
v_exp_f32 v120, v120
v_exp_f32 v121, v121
v_exp_f32 v122, v122
v_exp_f32 v123, v123
v_pk_add_f32 v[120:121], v[120:121], 1.0 op_sel_hi:[1,0]
v_pk_add_f32 v[122:123], v[122:123], 1.0 op_sel_hi:[1,0]
v_rcp_f32 v120, v120
v_rcp_f32 v121, v121
v_rcp_f32 v122, v122
v_rcp_f32 v123, v123
v_pk_mul_f32 v[104:105], v[104:105], v[120:121]
v_pk_mul_f32 v[106:107], v[106:107], v[122:123]
v_cvt_pk_bf16_f32 v24, v88, v89
v_cvt_pk_bf16_f32 v25, v90, v91
v_cvt_pk_bf16_f32 v26, v104, v105
v_cvt_pk_bf16_f32 v27, v106, v107
s_nop 1
v_permlane16_swap_b32 v24, v26
v_permlane16_swap_b32 v25, v27
s_nop 1
v_permlane32_swap_b32 v24, v26
v_permlane32_swap_b32 v25, v27
buffer_store_dwordx4 v[24:27], v13, s[24:27], s49 offen offset:2048 sc1
ds_write_b128 v14, v[24:27] offset:2048
v_pk_mul_f32 v[116:117], v[92:93], s[84:85]
v_pk_mul_f32 v[118:119], v[94:95], s[84:85]
v_exp_f32 v116, v116
v_exp_f32 v117, v117
v_exp_f32 v118, v118
v_exp_f32 v119, v119
v_pk_add_f32 v[116:117], v[116:117], 1.0 op_sel_hi:[1,0]
v_pk_add_f32 v[118:119], v[118:119], 1.0 op_sel_hi:[1,0]
v_rcp_f32 v116, v116
v_rcp_f32 v117, v117
v_rcp_f32 v118, v118
v_rcp_f32 v119, v119
v_pk_mul_f32 v[92:93], v[92:93], v[116:117]
v_pk_mul_f32 v[94:95], v[94:95], v[118:119]
v_pk_mul_f32 v[120:121], v[108:109], s[84:85]
v_pk_mul_f32 v[122:123], v[110:111], s[84:85]
v_exp_f32 v120, v120
v_exp_f32 v121, v121
v_exp_f32 v122, v122
v_exp_f32 v123, v123
v_pk_add_f32 v[120:121], v[120:121], 1.0 op_sel_hi:[1,0]
v_pk_add_f32 v[122:123], v[122:123], 1.0 op_sel_hi:[1,0]
v_rcp_f32 v120, v120
v_rcp_f32 v121, v121
v_rcp_f32 v122, v122
v_rcp_f32 v123, v123
v_pk_mul_f32 v[108:109], v[108:109], v[120:121]
v_pk_mul_f32 v[110:111], v[110:111], v[122:123]
v_cvt_pk_bf16_f32 v28, v92, v93
v_cvt_pk_bf16_f32 v29, v94, v95
v_cvt_pk_bf16_f32 v30, v108, v109
v_cvt_pk_bf16_f32 v31, v110, v111
s_nop 1
v_permlane16_swap_b32 v28, v30
v_permlane16_swap_b32 v29, v31
s_nop 1
v_permlane32_swap_b32 v28, v30
v_permlane32_swap_b32 v29, v31
buffer_store_dwordx4 v[28:31], v13, s[24:27], s49 offen offset:3072 sc1
ds_write_b128 v14, v[28:31] offset:3072
v_add_u32 v6, s36, v13
v_add_u32 v7, 1024, v6
v_add_u32 v8, 2048, v6
v_add_u32 v9, 3072, v6
v_lshrrev_b32 v14, 4, v0
v_lshlrev_b32 v14, 9, v14
v_and_b32 v15, 15, v0
v_lshl_add_u32 v14, v15, 4, v14
s_lshl_b32 s37, s37, 8
s_add_u32 s36, s36, s37
v_add_u32 v10, s36, v14
v_add_u32 v11, 2048, v10
v_add_u32 v2, 73728, v128
v_mov_b32 v3, v128
v_add_u32 v4, 36864, v128
v_add_u32 v124, 73728, v129
v_mov_b32 v125, v129
v_add_u32 v126, 36864, v129
v_pk_mov_b32 v[80:81], 0, 0
v_pk_mov_b32 v[82:83], 0, 0
v_pk_mov_b32 v[84:85], 0, 0
v_pk_mov_b32 v[86:87], 0, 0
v_pk_mov_b32 v[88:89], 0, 0
v_pk_mov_b32 v[90:91], 0, 0
v_pk_mov_b32 v[92:93], 0, 0
v_pk_mov_b32 v[94:95], 0, 0
v_pk_mov_b32 v[96:97], 0, 0
v_pk_mov_b32 v[98:99], 0, 0
v_pk_mov_b32 v[100:101], 0, 0
v_pk_mov_b32 v[102:103], 0, 0
v_pk_mov_b32 v[104:105], 0, 0
v_pk_mov_b32 v[106:107], 0, 0
v_pk_mov_b32 v[108:109], 0, 0
v_pk_mov_b32 v[110:111], 0, 0
v_pk_mov_b32 v[112:113], 0, 0
v_pk_mov_b32 v[114:115], 0, 0
v_mov_b32 v15, 1
s_mov_b32 s48, 1
s_waitcnt lgkmcnt(0)
s_barrier
ds_read_b128 v[36:39], v6 offset:0
ds_read_b64_tr_b16 v[16:17], v2 offset:0
ds_read_b64_tr_b16 v[18:19], v2 offset:288
ds_read_b64_tr_b16 v[20:21], v2 offset:64
ds_read_b64_tr_b16 v[22:23], v2 offset:352
ds_read_b128 v[40:43], v7 offset:0
ds_read_b64_tr_b16 v[24:25], v2 offset:4608
ds_read_b64_tr_b16 v[26:27], v2 offset:4896
ds_read_b64_tr_b16 v[28:29], v2 offset:4672
ds_read_b64_tr_b16 v[30:31], v2 offset:4960
ds_read_b128 v[44:47], v10 offset:0
ds_read_b64_tr_b16 v[32:33], v124 offset:0
ds_read_b64_tr_b16 v[34:35], v124 offset:288
s_waitcnt lgkmcnt(10)
v_mfma_f32_32x32x16_bf16 v[80:95], v[16:19], v[36:39], v[80:95]
ds_read_b128 v[68:71], v8 offset:0
ds_read_b64_tr_b16 v[48:49], v2 offset:9216
ds_read_b64_tr_b16 v[50:51], v2 offset:9504
s_waitcnt lgkmcnt(11)
v_mfma_f32_32x32x16_bf16 v[96:111], v[20:23], v[36:39], v[96:111]
ds_read_b64_tr_b16 v[52:53], v2 offset:9280
ds_read_b64_tr_b16 v[54:55], v2 offset:9568
ds_read_b128 v[72:75], v9 offset:0
s_waitcnt lgkmcnt(11)
v_mfma_f32_32x32x16_bf16 v[80:95], v[24:27], v[40:43], v[80:95]
ds_read_b64_tr_b16 v[56:57], v2 offset:13824
ds_read_b64_tr_b16 v[58:59], v2 offset:14112
ds_read_b64_tr_b16 v[60:61], v2 offset:13888
s_waitcnt lgkmcnt(12)
v_mfma_f32_32x32x16_bf16 v[96:111], v[28:31], v[40:43], v[96:111]
ds_read_b64_tr_b16 v[62:63], v2 offset:14176
ds_read_b128 v[76:79], v11 offset:0
ds_read_b64_tr_b16 v[64:65], v124 offset:9216
s_waitcnt lgkmcnt(12)
v_mfma_f32_16x16x32_bf16 v[112:115], v[32:35], v[44:47], v[112:115]
ds_read_b64_tr_b16 v[66:67], v124 offset:9504
s_barrier
s_waitcnt lgkmcnt(10)
v_mfma_f32_32x32x16_bf16 v[80:95], v[48:51], v[68:71], v[80:95]
ds_read_b128 v[36:39], v6 offset:4096
ds_read_b64_tr_b16 v[16:17], v2 offset:18432
ds_read_b64_tr_b16 v[18:19], v2 offset:18720
s_waitcnt lgkmcnt(11)
v_mfma_f32_32x32x16_bf16 v[96:111], v[52:55], v[68:71], v[96:111]
ds_read_b64_tr_b16 v[20:21], v2 offset:18496
ds_read_b64_tr_b16 v[22:23], v2 offset:18784
ds_read_b128 v[40:43], v7 offset:4096
s_waitcnt lgkmcnt(11)
v_mfma_f32_32x32x16_bf16 v[80:95], v[56:59], v[72:75], v[80:95]
ds_read_b64_tr_b16 v[24:25], v2 offset:23040
ds_read_b64_tr_b16 v[26:27], v2 offset:23328
ds_read_b64_tr_b16 v[28:29], v2 offset:23104
s_waitcnt lgkmcnt(12)
v_mfma_f32_32x32x16_bf16 v[96:111], v[60:63], v[72:75], v[96:111]
ds_read_b64_tr_b16 v[30:31], v2 offset:23392
ds_read_b128 v[44:47], v10 offset:4096
ds_read_b64_tr_b16 v[32:33], v124 offset:18432
s_waitcnt lgkmcnt(12)
v_mfma_f32_16x16x32_bf16 v[112:115], v[64:67], v[76:79], v[112:115]
ds_read_b64_tr_b16 v[34:35], v124 offset:18720
s_waitcnt lgkmcnt(10)
v_mfma_f32_32x32x16_bf16 v[80:95], v[16:19], v[36:39], v[80:95]
ds_read_b128 v[68:71], v8 offset:4096
ds_read_b64_tr_b16 v[48:49], v2 offset:27648
ds_read_b64_tr_b16 v[50:51], v2 offset:27936
s_waitcnt lgkmcnt(11)
v_mfma_f32_32x32x16_bf16 v[96:111], v[20:23], v[36:39], v[96:111]
ds_read_b64_tr_b16 v[52:53], v2 offset:27712
ds_read_b64_tr_b16 v[54:55], v2 offset:28000
ds_read_b128 v[72:75], v9 offset:4096
s_waitcnt lgkmcnt(11)
v_mfma_f32_32x32x16_bf16 v[80:95], v[24:27], v[40:43], v[80:95]
ds_read_b64_tr_b16 v[56:57], v2 offset:32256
ds_read_b64_tr_b16 v[58:59], v2 offset:32544
ds_read_b64_tr_b16 v[60:61], v2 offset:32320
s_waitcnt lgkmcnt(12)
v_mfma_f32_32x32x16_bf16 v[96:111], v[28:31], v[40:43], v[96:111]
ds_read_b64_tr_b16 v[62:63], v2 offset:32608
ds_read_b128 v[76:79], v11 offset:4096
ds_read_b64_tr_b16 v[64:65], v124 offset:27648
s_waitcnt lgkmcnt(12)
v_mfma_f32_16x16x32_bf16 v[112:115], v[32:35], v[44:47], v[112:115]
ds_read_b64_tr_b16 v[66:67], v124 offset:27936
s_waitcnt vmcnt(0)
v_cmp_ne_u32 vcc, 1, v12
s_cbranch_vccz L_PGXC
s_mov_b32 s39, 0
L_PGC:
s_add_u32 s39, s39, 1
s_cmp_gt_u32 s39, 131072
s_cbranch_scc1 L_PGXC
buffer_load_dword v12, off, s[44:47], 0 sc1
s_waitcnt vmcnt(0)
v_cmp_ne_u32 vcc, 1, v12
s_cbranch_vccnz L_PGC
L_PGXC:
s_mov_b64 exec, 1
buffer_store_dword v15, off, s[24:27], s51 sc1
s_mov_b64 exec, -1
s_barrier
s_barrier
s_waitcnt lgkmcnt(10)
v_mfma_f32_32x32x16_bf16 v[80:95], v[48:51], v[68:71], v[80:95]
ds_read_b128 v[36:39], v6 offset:8192
ds_read_b64_tr_b16 v[16:17], v3 offset:0
ds_read_b64_tr_b16 v[18:19], v3 offset:288
s_waitcnt lgkmcnt(11)
v_mfma_f32_32x32x16_bf16 v[96:111], v[52:55], v[68:71], v[96:111]
ds_read_b64_tr_b16 v[20:21], v3 offset:64
ds_read_b64_tr_b16 v[22:23], v3 offset:352
ds_read_b128 v[40:43], v7 offset:8192
s_waitcnt lgkmcnt(11)
v_mfma_f32_32x32x16_bf16 v[80:95], v[56:59], v[72:75], v[80:95]
ds_read_b64_tr_b16 v[24:25], v3 offset:4608
ds_read_b64_tr_b16 v[26:27], v3 offset:4896
ds_read_b64_tr_b16 v[28:29], v3 offset:4672
s_waitcnt lgkmcnt(12)
v_mfma_f32_32x32x16_bf16 v[96:111], v[60:63], v[72:75], v[96:111]
ds_read_b64_tr_b16 v[30:31], v3 offset:4960
ds_read_b128 v[44:47], v10 offset:8192
ds_read_b64_tr_b16 v[32:33], v125 offset:0
s_waitcnt lgkmcnt(12)
v_mfma_f32_16x16x32_bf16 v[112:115], v[64:67], v[76:79], v[112:115]
ds_read_b64_tr_b16 v[34:35], v125 offset:288
s_waitcnt lgkmcnt(10)
v_mfma_f32_32x32x16_bf16 v[80:95], v[16:19], v[36:39], v[80:95]
ds_read_b128 v[68:71], v8 offset:8192
ds_read_b64_tr_b16 v[48:49], v3 offset:9216
ds_read_b64_tr_b16 v[50:51], v3 offset:9504
s_waitcnt lgkmcnt(11)
v_mfma_f32_32x32x16_bf16 v[96:111], v[20:23], v[36:39], v[96:111]
ds_read_b64_tr_b16 v[52:53], v3 offset:9280
ds_read_b64_tr_b16 v[54:55], v3 offset:9568
ds_read_b128 v[72:75], v9 offset:8192
s_waitcnt lgkmcnt(11)
v_mfma_f32_32x32x16_bf16 v[80:95], v[24:27], v[40:43], v[80:95]
ds_read_b64_tr_b16 v[56:57], v3 offset:13824
ds_read_b64_tr_b16 v[58:59], v3 offset:14112
ds_read_b64_tr_b16 v[60:61], v3 offset:13888
s_waitcnt lgkmcnt(12)
v_mfma_f32_32x32x16_bf16 v[96:111], v[28:31], v[40:43], v[96:111]
ds_read_b64_tr_b16 v[62:63], v3 offset:14176
ds_read_b128 v[76:79], v11 offset:8192
ds_read_b64_tr_b16 v[64:65], v125 offset:9216
s_waitcnt lgkmcnt(12)
v_mfma_f32_16x16x32_bf16 v[112:115], v[32:35], v[44:47], v[112:115]
ds_read_b64_tr_b16 v[66:67], v125 offset:9504
s_barrier
s_waitcnt lgkmcnt(10)
v_mfma_f32_32x32x16_bf16 v[80:95], v[48:51], v[68:71], v[80:95]
ds_read_b128 v[36:39], v6 offset:12288
ds_read_b64_tr_b16 v[16:17], v3 offset:18432
ds_read_b64_tr_b16 v[18:19], v3 offset:18720
s_waitcnt lgkmcnt(11)
v_mfma_f32_32x32x16_bf16 v[96:111], v[52:55], v[68:71], v[96:111]
ds_read_b64_tr_b16 v[20:21], v3 offset:18496
ds_read_b64_tr_b16 v[22:23], v3 offset:18784
ds_read_b128 v[40:43], v7 offset:12288
s_waitcnt lgkmcnt(11)
v_mfma_f32_32x32x16_bf16 v[80:95], v[56:59], v[72:75], v[80:95]
ds_read_b64_tr_b16 v[24:25], v3 offset:23040
ds_read_b64_tr_b16 v[26:27], v3 offset:23328
ds_read_b64_tr_b16 v[28:29], v3 offset:23104
s_waitcnt lgkmcnt(12)
v_mfma_f32_32x32x16_bf16 v[96:111], v[60:63], v[72:75], v[96:111]
ds_read_b64_tr_b16 v[30:31], v3 offset:23392
ds_read_b128 v[44:47], v10 offset:12288
ds_read_b64_tr_b16 v[32:33], v125 offset:18432
s_waitcnt lgkmcnt(12)
v_mfma_f32_16x16x32_bf16 v[112:115], v[64:67], v[76:79], v[112:115]
ds_read_b64_tr_b16 v[34:35], v125 offset:18720
s_waitcnt lgkmcnt(10)
v_mfma_f32_32x32x16_bf16 v[80:95], v[16:19], v[36:39], v[80:95]
ds_read_b128 v[68:71], v8 offset:12288
ds_read_b64_tr_b16 v[48:49], v3 offset:27648
ds_read_b64_tr_b16 v[50:51], v3 offset:27936
s_waitcnt lgkmcnt(11)
v_mfma_f32_32x32x16_bf16 v[96:111], v[20:23], v[36:39], v[96:111]
ds_read_b64_tr_b16 v[52:53], v3 offset:27712
ds_read_b64_tr_b16 v[54:55], v3 offset:28000
ds_read_b128 v[72:75], v9 offset:12288
s_waitcnt lgkmcnt(11)
v_mfma_f32_32x32x16_bf16 v[80:95], v[24:27], v[40:43], v[80:95]
ds_read_b64_tr_b16 v[56:57], v3 offset:32256
ds_read_b64_tr_b16 v[58:59], v3 offset:32544
ds_read_b64_tr_b16 v[60:61], v3 offset:32320
s_waitcnt lgkmcnt(12)
v_mfma_f32_32x32x16_bf16 v[96:111], v[28:31], v[40:43], v[96:111]
ds_read_b64_tr_b16 v[62:63], v3 offset:32608
ds_read_b128 v[76:79], v11 offset:12288
ds_read_b64_tr_b16 v[64:65], v125 offset:27648
s_waitcnt lgkmcnt(12)
v_mfma_f32_16x16x32_bf16 v[112:115], v[32:35], v[44:47], v[112:115]
ds_read_b64_tr_b16 v[66:67], v125 offset:27936
s_barrier
s_waitcnt lgkmcnt(10)
v_mfma_f32_32x32x16_bf16 v[80:95], v[48:51], v[68:71], v[80:95]
ds_read_b128 v[36:39], v6 offset:16384
ds_read_b64_tr_b16 v[16:17], v4 offset:0
ds_read_b64_tr_b16 v[18:19], v4 offset:288
s_waitcnt lgkmcnt(11)
v_mfma_f32_32x32x16_bf16 v[96:111], v[52:55], v[68:71], v[96:111]
ds_read_b64_tr_b16 v[20:21], v4 offset:64
ds_read_b64_tr_b16 v[22:23], v4 offset:352
ds_read_b128 v[40:43], v7 offset:16384
s_waitcnt lgkmcnt(11)
v_mfma_f32_32x32x16_bf16 v[80:95], v[56:59], v[72:75], v[80:95]
ds_read_b64_tr_b16 v[24:25], v4 offset:4608
ds_read_b64_tr_b16 v[26:27], v4 offset:4896
ds_read_b64_tr_b16 v[28:29], v4 offset:4672
s_waitcnt lgkmcnt(12)
v_mfma_f32_32x32x16_bf16 v[96:111], v[60:63], v[72:75], v[96:111]
ds_read_b64_tr_b16 v[30:31], v4 offset:4960
ds_read_b128 v[44:47], v10 offset:16384
ds_read_b64_tr_b16 v[32:33], v126 offset:0
s_waitcnt lgkmcnt(12)
v_mfma_f32_16x16x32_bf16 v[112:115], v[64:67], v[76:79], v[112:115]
ds_read_b64_tr_b16 v[34:35], v126 offset:288
s_waitcnt lgkmcnt(10)
v_mfma_f32_32x32x16_bf16 v[80:95], v[16:19], v[36:39], v[80:95]
ds_read_b128 v[68:71], v8 offset:16384
ds_read_b64_tr_b16 v[48:49], v4 offset:9216
ds_read_b64_tr_b16 v[50:51], v4 offset:9504
s_waitcnt lgkmcnt(11)
v_mfma_f32_32x32x16_bf16 v[96:111], v[20:23], v[36:39], v[96:111]
ds_read_b64_tr_b16 v[52:53], v4 offset:9280
ds_read_b64_tr_b16 v[54:55], v4 offset:9568
ds_read_b128 v[72:75], v9 offset:16384
s_waitcnt lgkmcnt(11)
v_mfma_f32_32x32x16_bf16 v[80:95], v[24:27], v[40:43], v[80:95]
ds_read_b64_tr_b16 v[56:57], v4 offset:13824
ds_read_b64_tr_b16 v[58:59], v4 offset:14112
ds_read_b64_tr_b16 v[60:61], v4 offset:13888
s_waitcnt lgkmcnt(12)
v_mfma_f32_32x32x16_bf16 v[96:111], v[28:31], v[40:43], v[96:111]
ds_read_b64_tr_b16 v[62:63], v4 offset:14176
ds_read_b128 v[76:79], v11 offset:16384
ds_read_b64_tr_b16 v[64:65], v126 offset:9216
s_waitcnt lgkmcnt(12)
v_mfma_f32_16x16x32_bf16 v[112:115], v[32:35], v[44:47], v[112:115]
ds_read_b64_tr_b16 v[66:67], v126 offset:9504
s_barrier
s_waitcnt lgkmcnt(10)
v_mfma_f32_32x32x16_bf16 v[80:95], v[48:51], v[68:71], v[80:95]
ds_read_b128 v[36:39], v6 offset:0
ds_read_b64_tr_b16 v[16:17], v4 offset:18432
ds_read_b64_tr_b16 v[18:19], v4 offset:18720
s_waitcnt lgkmcnt(11)
v_mfma_f32_32x32x16_bf16 v[96:111], v[52:55], v[68:71], v[96:111]
ds_read_b64_tr_b16 v[20:21], v4 offset:18496
ds_read_b64_tr_b16 v[22:23], v4 offset:18784
ds_read_b128 v[40:43], v7 offset:0
s_waitcnt lgkmcnt(11)
v_mfma_f32_32x32x16_bf16 v[80:95], v[56:59], v[72:75], v[80:95]
ds_read_b64_tr_b16 v[24:25], v4 offset:23040
ds_read_b64_tr_b16 v[26:27], v4 offset:23328
ds_read_b64_tr_b16 v[28:29], v4 offset:23104
s_waitcnt lgkmcnt(12)
v_mfma_f32_32x32x16_bf16 v[96:111], v[60:63], v[72:75], v[96:111]
ds_read_b64_tr_b16 v[30:31], v4 offset:23392
ds_read_b128 v[44:47], v10 offset:0
ds_read_b64_tr_b16 v[32:33], v126 offset:18432
s_waitcnt lgkmcnt(12)
v_mfma_f32_16x16x32_bf16 v[112:115], v[64:67], v[76:79], v[112:115]
ds_read_b64_tr_b16 v[34:35], v126 offset:18720
s_waitcnt lgkmcnt(10)
v_mfma_f32_32x32x16_bf16 v[80:95], v[16:19], v[36:39], v[80:95]
ds_read_b128 v[68:71], v8 offset:0
ds_read_b64_tr_b16 v[48:49], v4 offset:27648
ds_read_b64_tr_b16 v[50:51], v4 offset:27936
s_waitcnt lgkmcnt(11)
v_mfma_f32_32x32x16_bf16 v[96:111], v[20:23], v[36:39], v[96:111]
ds_read_b64_tr_b16 v[52:53], v4 offset:27712
ds_read_b64_tr_b16 v[54:55], v4 offset:28000
ds_read_b128 v[72:75], v9 offset:0
s_waitcnt lgkmcnt(11)
v_mfma_f32_32x32x16_bf16 v[80:95], v[24:27], v[40:43], v[80:95]
ds_read_b64_tr_b16 v[56:57], v4 offset:32256
ds_read_b64_tr_b16 v[58:59], v4 offset:32544
ds_read_b64_tr_b16 v[60:61], v4 offset:32320
s_waitcnt lgkmcnt(12)
v_mfma_f32_32x32x16_bf16 v[96:111], v[28:31], v[40:43], v[96:111]
ds_read_b64_tr_b16 v[62:63], v4 offset:32608
ds_read_b128 v[76:79], v11 offset:0
ds_read_b64_tr_b16 v[64:65], v126 offset:27648
s_waitcnt lgkmcnt(12)
v_mfma_f32_16x16x32_bf16 v[112:115], v[32:35], v[44:47], v[112:115]
ds_read_b64_tr_b16 v[66:67], v126 offset:27936
s_barrier
s_waitcnt lgkmcnt(10)
v_mfma_f32_32x32x16_bf16 v[80:95], v[48:51], v[68:71], v[80:95]
ds_read_b128 v[36:39], v6 offset:4096
ds_read_b64_tr_b16 v[16:17], v2 offset:0
ds_read_b64_tr_b16 v[18:19], v2 offset:288
s_waitcnt lgkmcnt(11)
v_mfma_f32_32x32x16_bf16 v[96:111], v[52:55], v[68:71], v[96:111]
ds_read_b64_tr_b16 v[20:21], v2 offset:64
ds_read_b64_tr_b16 v[22:23], v2 offset:352
ds_read_b128 v[40:43], v7 offset:4096
s_waitcnt lgkmcnt(11)
v_mfma_f32_32x32x16_bf16 v[80:95], v[56:59], v[72:75], v[80:95]
ds_read_b64_tr_b16 v[24:25], v2 offset:4608
ds_read_b64_tr_b16 v[26:27], v2 offset:4896
ds_read_b64_tr_b16 v[28:29], v2 offset:4672
s_waitcnt lgkmcnt(12)
v_mfma_f32_32x32x16_bf16 v[96:111], v[60:63], v[72:75], v[96:111]
ds_read_b64_tr_b16 v[30:31], v2 offset:4960
ds_read_b128 v[44:47], v10 offset:4096
ds_read_b64_tr_b16 v[32:33], v124 offset:0
s_waitcnt lgkmcnt(12)
v_mfma_f32_16x16x32_bf16 v[112:115], v[64:67], v[76:79], v[112:115]
ds_read_b64_tr_b16 v[34:35], v124 offset:288
s_waitcnt lgkmcnt(10)
v_mfma_f32_32x32x16_bf16 v[80:95], v[16:19], v[36:39], v[80:95]
ds_read_b128 v[68:71], v8 offset:4096
ds_read_b64_tr_b16 v[48:49], v2 offset:9216
ds_read_b64_tr_b16 v[50:51], v2 offset:9504
s_waitcnt lgkmcnt(11)
v_mfma_f32_32x32x16_bf16 v[96:111], v[20:23], v[36:39], v[96:111]
ds_read_b64_tr_b16 v[52:53], v2 offset:9280
ds_read_b64_tr_b16 v[54:55], v2 offset:9568
ds_read_b128 v[72:75], v9 offset:4096
s_waitcnt lgkmcnt(11)
v_mfma_f32_32x32x16_bf16 v[80:95], v[24:27], v[40:43], v[80:95]
ds_read_b64_tr_b16 v[56:57], v2 offset:13824
ds_read_b64_tr_b16 v[58:59], v2 offset:14112
ds_read_b64_tr_b16 v[60:61], v2 offset:13888
s_waitcnt lgkmcnt(12)
v_mfma_f32_32x32x16_bf16 v[96:111], v[28:31], v[40:43], v[96:111]
ds_read_b64_tr_b16 v[62:63], v2 offset:14176
ds_read_b128 v[76:79], v11 offset:4096
ds_read_b64_tr_b16 v[64:65], v124 offset:9216
s_waitcnt lgkmcnt(12)
v_mfma_f32_16x16x32_bf16 v[112:115], v[32:35], v[44:47], v[112:115]
ds_read_b64_tr_b16 v[66:67], v124 offset:9504
s_barrier
s_waitcnt lgkmcnt(10)
v_mfma_f32_32x32x16_bf16 v[80:95], v[48:51], v[68:71], v[80:95]
ds_read_b128 v[36:39], v6 offset:8192
ds_read_b64_tr_b16 v[16:17], v2 offset:18432
ds_read_b64_tr_b16 v[18:19], v2 offset:18720
s_waitcnt lgkmcnt(11)
v_mfma_f32_32x32x16_bf16 v[96:111], v[52:55], v[68:71], v[96:111]
ds_read_b64_tr_b16 v[20:21], v2 offset:18496
ds_read_b64_tr_b16 v[22:23], v2 offset:18784
ds_read_b128 v[40:43], v7 offset:8192
s_waitcnt lgkmcnt(11)
v_mfma_f32_32x32x16_bf16 v[80:95], v[56:59], v[72:75], v[80:95]
ds_read_b64_tr_b16 v[24:25], v2 offset:23040
ds_read_b64_tr_b16 v[26:27], v2 offset:23328
ds_read_b64_tr_b16 v[28:29], v2 offset:23104
s_waitcnt lgkmcnt(12)
v_mfma_f32_32x32x16_bf16 v[96:111], v[60:63], v[72:75], v[96:111]
ds_read_b64_tr_b16 v[30:31], v2 offset:23392
ds_read_b128 v[44:47], v10 offset:8192
ds_read_b64_tr_b16 v[32:33], v124 offset:18432
s_waitcnt lgkmcnt(12)
v_mfma_f32_16x16x32_bf16 v[112:115], v[64:67], v[76:79], v[112:115]
ds_read_b64_tr_b16 v[34:35], v124 offset:18720
s_waitcnt lgkmcnt(10)
v_mfma_f32_32x32x16_bf16 v[80:95], v[16:19], v[36:39], v[80:95]
ds_read_b128 v[68:71], v8 offset:8192
ds_read_b64_tr_b16 v[48:49], v2 offset:27648
ds_read_b64_tr_b16 v[50:51], v2 offset:27936
s_waitcnt lgkmcnt(11)
v_mfma_f32_32x32x16_bf16 v[96:111], v[20:23], v[36:39], v[96:111]
ds_read_b64_tr_b16 v[52:53], v2 offset:27712
ds_read_b64_tr_b16 v[54:55], v2 offset:28000
ds_read_b128 v[72:75], v9 offset:8192
s_waitcnt lgkmcnt(11)
v_mfma_f32_32x32x16_bf16 v[80:95], v[24:27], v[40:43], v[80:95]
ds_read_b64_tr_b16 v[56:57], v2 offset:32256
ds_read_b64_tr_b16 v[58:59], v2 offset:32544
ds_read_b64_tr_b16 v[60:61], v2 offset:32320
s_waitcnt lgkmcnt(12)
v_mfma_f32_32x32x16_bf16 v[96:111], v[28:31], v[40:43], v[96:111]
ds_read_b64_tr_b16 v[62:63], v2 offset:32608
ds_read_b128 v[76:79], v11 offset:8192
ds_read_b64_tr_b16 v[64:65], v124 offset:27648
s_waitcnt lgkmcnt(12)
v_mfma_f32_16x16x32_bf16 v[112:115], v[32:35], v[44:47], v[112:115]
ds_read_b64_tr_b16 v[66:67], v124 offset:27936
s_barrier
s_waitcnt lgkmcnt(10)
v_mfma_f32_32x32x16_bf16 v[80:95], v[48:51], v[68:71], v[80:95]
ds_read_b128 v[36:39], v6 offset:12288
ds_read_b64_tr_b16 v[16:17], v3 offset:0
ds_read_b64_tr_b16 v[18:19], v3 offset:288
s_waitcnt lgkmcnt(11)
v_mfma_f32_32x32x16_bf16 v[96:111], v[52:55], v[68:71], v[96:111]
ds_read_b64_tr_b16 v[20:21], v3 offset:64
ds_read_b64_tr_b16 v[22:23], v3 offset:352
ds_read_b128 v[40:43], v7 offset:12288
s_waitcnt lgkmcnt(11)
v_mfma_f32_32x32x16_bf16 v[80:95], v[56:59], v[72:75], v[80:95]
ds_read_b64_tr_b16 v[24:25], v3 offset:4608
ds_read_b64_tr_b16 v[26:27], v3 offset:4896
ds_read_b64_tr_b16 v[28:29], v3 offset:4672
s_waitcnt lgkmcnt(12)
v_mfma_f32_32x32x16_bf16 v[96:111], v[60:63], v[72:75], v[96:111]
ds_read_b64_tr_b16 v[30:31], v3 offset:4960
ds_read_b128 v[44:47], v10 offset:12288
ds_read_b64_tr_b16 v[32:33], v125 offset:0
s_waitcnt lgkmcnt(12)
v_mfma_f32_16x16x32_bf16 v[112:115], v[64:67], v[76:79], v[112:115]
ds_read_b64_tr_b16 v[34:35], v125 offset:288
s_waitcnt lgkmcnt(10)
v_mfma_f32_32x32x16_bf16 v[80:95], v[16:19], v[36:39], v[80:95]
ds_read_b128 v[68:71], v8 offset:12288
ds_read_b64_tr_b16 v[48:49], v3 offset:9216
ds_read_b64_tr_b16 v[50:51], v3 offset:9504
s_waitcnt lgkmcnt(11)
v_mfma_f32_32x32x16_bf16 v[96:111], v[20:23], v[36:39], v[96:111]
ds_read_b64_tr_b16 v[52:53], v3 offset:9280
ds_read_b64_tr_b16 v[54:55], v3 offset:9568
ds_read_b128 v[72:75], v9 offset:12288
s_waitcnt lgkmcnt(11)
v_mfma_f32_32x32x16_bf16 v[80:95], v[24:27], v[40:43], v[80:95]
ds_read_b64_tr_b16 v[56:57], v3 offset:13824
ds_read_b64_tr_b16 v[58:59], v3 offset:14112
ds_read_b64_tr_b16 v[60:61], v3 offset:13888
s_waitcnt lgkmcnt(12)
v_mfma_f32_32x32x16_bf16 v[96:111], v[28:31], v[40:43], v[96:111]
ds_read_b64_tr_b16 v[62:63], v3 offset:14176
ds_read_b128 v[76:79], v11 offset:12288
ds_read_b64_tr_b16 v[64:65], v125 offset:9216
s_waitcnt lgkmcnt(12)
v_mfma_f32_16x16x32_bf16 v[112:115], v[32:35], v[44:47], v[112:115]
ds_read_b64_tr_b16 v[66:67], v125 offset:9504
s_waitcnt lgkmcnt(10)
v_mfma_f32_32x32x16_bf16 v[80:95], v[48:51], v[68:71], v[80:95]
s_waitcnt lgkmcnt(8)
v_mfma_f32_32x32x16_bf16 v[96:111], v[52:55], v[68:71], v[96:111]
s_waitcnt lgkmcnt(5)
v_mfma_f32_32x32x16_bf16 v[80:95], v[56:59], v[72:75], v[80:95]
s_waitcnt lgkmcnt(3)
v_mfma_f32_32x32x16_bf16 v[96:111], v[60:63], v[72:75], v[96:111]
s_waitcnt lgkmcnt(0)
v_mfma_f32_16x16x32_bf16 v[112:115], v[64:67], v[76:79], v[112:115]
L_EPI2:
v_bfe_u32 v12, v0, 3, 2
v_mul_u32_u24 v12, 18432, v12
v_lshrrev_b32 v13, 5, v0
v_lshl_add_u32 v12, v13, 7, v12
v_and_b32 v13, 7, v0
v_lshl_add_u32 v12, v13, 4, v12
v_lshrrev_b32 v14, 4, v0
v_lshl_add_u32 v14, v14, 3, v13
v_bfe_u32 v13, v0, 3, 1
v_mul_u32_u24 v13, 18432, v13
v_lshl_add_u32 v13, v14, 3, v13
s_mov_b32 s84, 0xfffffffe
v_cvt_pk_bf16_f32 v16, v80, v81
v_cvt_pk_bf16_f32 v17, v82, v83
v_cvt_pk_bf16_f32 v18, v84, v85
v_cvt_pk_bf16_f32 v19, v86, v87
v_min_u32 v16, s84, v16
v_min_u32 v17, s84, v17
v_min_u32 v18, s84, v18
v_min_u32 v19, s84, v19
buffer_store_dwordx4 v[16:19], v12, s[24:27], s52 offen offset:0 sc1
v_cvt_pk_bf16_f32 v20, v88, v89
v_cvt_pk_bf16_f32 v21, v90, v91
v_cvt_pk_bf16_f32 v22, v92, v93
v_cvt_pk_bf16_f32 v23, v94, v95
v_min_u32 v20, s84, v20
v_min_u32 v21, s84, v21
v_min_u32 v22, s84, v22
v_min_u32 v23, s84, v23
buffer_store_dwordx4 v[20:23], v12, s[24:27], s52 offen offset:256 sc1
v_cvt_pk_bf16_f32 v24, v96, v97
v_cvt_pk_bf16_f32 v25, v98, v99
v_cvt_pk_bf16_f32 v26, v100, v101
v_cvt_pk_bf16_f32 v27, v102, v103
v_min_u32 v24, s84, v24
v_min_u32 v25, s84, v25
v_min_u32 v26, s84, v26
v_min_u32 v27, s84, v27
buffer_store_dwordx4 v[24:27], v12, s[24:27], s52 offen offset:512 sc1
v_cvt_pk_bf16_f32 v28, v104, v105
v_cvt_pk_bf16_f32 v29, v106, v107
v_cvt_pk_bf16_f32 v30, v108, v109
v_cvt_pk_bf16_f32 v31, v110, v111
v_min_u32 v28, s84, v28
v_min_u32 v29, s84, v29
v_min_u32 v30, s84, v30
v_min_u32 v31, s84, v31
buffer_store_dwordx4 v[28:31], v12, s[24:27], s52 offen offset:768 sc1
v_cvt_pk_bf16_f32 v32, v112, v113
v_cvt_pk_bf16_f32 v33, v114, v115
v_min_u32 v32, s84, v32
v_min_u32 v33, s84, v33
buffer_store_dwordx2 v[32:33], v13, s[24:27], s55 offen sc1
s_waitcnt vmcnt(0)
s_barrier
s_cmp_eq_u32 s32, 0
s_cbranch_scc0 L_CDONE
v_min_u32 v100, 31, v0
v_lshlrev_b32 v104, 3, v100
s_add_u32 s36, s58, 2048
v_and_b32 v101, 7, v100
v_mul_u32_u24 v101, 1152, v101
v_lshrrev_b32 v100, 3, v100
v_lshl_add_u32 v105, v100, 3, v101
s_mov_b32 s38, 256
s_lshl_b32 s37, s31, 3
s_add_u32 s37, s37, s29
s_mul_i32 s37, s37, 9216
s_add_u32 s38, s38, s37
s_mul_i32 s37, s30, 288
s_add_u32 s38, s38, s37
s_mov_b32 s16, s10
s_mov_b32 s17, s11
s_mov_b32 s18, 589824
s_mov_b32 s19, 0x20000
s_mov_b32 s39, 0
L_RPC:
s_mov_b32 s37, s36
buffer_load_dwordx2 v[80:81], v104, s[24:27], s37 offen sc1
s_add_u32 s37, s37, 2304
buffer_load_dwordx2 v[82:83], v104, s[24:27], s37 offen sc1
s_add_u32 s37, s37, 2304
buffer_load_dwordx2 v[84:85], v104, s[24:27], s37 offen sc1
s_add_u32 s37, s37, 2304
buffer_load_dwordx2 v[86:87], v104, s[24:27], s37 offen sc1
s_add_u32 s37, s37, 2304
buffer_load_dwordx2 v[88:89], v104, s[24:27], s37 offen sc1
s_add_u32 s37, s37, 2304
buffer_load_dwordx2 v[90:91], v104, s[24:27], s37 offen sc1
s_add_u32 s37, s37, 2304
buffer_load_dwordx2 v[92:93], v104, s[24:27], s37 offen sc1
s_add_u32 s37, s37, 2304
buffer_load_dwordx2 v[94:95], v104, s[24:27], s37 offen sc1
s_add_u32 s39, s39, 1
s_cmp_gt_u32 s39, 131072
s_cbranch_scc1 L_RPXC
s_waitcnt vmcnt(0)
v_max3_u32 v100, v80, v81, v82
v_max3_u32 v100, v100, v83, v84
v_max3_u32 v100, v100, v85, v86
v_max3_u32 v100, v100, v87, v88
v_max3_u32 v100, v100, v89, v90
v_max3_u32 v100, v100, v91, v92
v_max3_u32 v100, v100, v93, v94
v_max_u32 v100, v100, v95
v_cmp_eq_u32 vcc, -1, v100
s_cbranch_vccnz L_RPC
L_RPXC:
s_waitcnt vmcnt(0)
v_lshlrev_b32 v96, 16, v80
v_and_b32 v97, 0xffff0000, v80
v_lshlrev_b32 v98, 16, v81
v_and_b32 v99, 0xffff0000, v81
v_lshlrev_b32 v100, 16, v82
v_and_b32 v101, 0xffff0000, v82
v_lshlrev_b32 v102, 16, v83
v_and_b32 v103, 0xffff0000, v83
v_add_f32 v96, v96, v100
v_add_f32 v97, v97, v101
v_add_f32 v98, v98, v102
v_add_f32 v99, v99, v103
v_lshlrev_b32 v100, 16, v84
v_and_b32 v101, 0xffff0000, v84
v_lshlrev_b32 v102, 16, v85
v_and_b32 v103, 0xffff0000, v85
v_add_f32 v96, v96, v100
v_add_f32 v97, v97, v101
v_add_f32 v98, v98, v102
v_add_f32 v99, v99, v103
v_lshlrev_b32 v100, 16, v86
v_and_b32 v101, 0xffff0000, v86
v_lshlrev_b32 v102, 16, v87
v_and_b32 v103, 0xffff0000, v87
v_add_f32 v96, v96, v100
v_add_f32 v97, v97, v101
v_add_f32 v98, v98, v102
v_add_f32 v99, v99, v103
v_lshlrev_b32 v100, 16, v88
v_and_b32 v101, 0xffff0000, v88
v_lshlrev_b32 v102, 16, v89
v_and_b32 v103, 0xffff0000, v89
v_add_f32 v96, v96, v100
v_add_f32 v97, v97, v101
v_add_f32 v98, v98, v102
v_add_f32 v99, v99, v103
v_lshlrev_b32 v100, 16, v90
v_and_b32 v101, 0xffff0000, v90
v_lshlrev_b32 v102, 16, v91
v_and_b32 v103, 0xffff0000, v91
v_add_f32 v96, v96, v100
v_add_f32 v97, v97, v101
v_add_f32 v98, v98, v102
v_add_f32 v99, v99, v103
v_lshlrev_b32 v100, 16, v92
v_and_b32 v101, 0xffff0000, v92
v_lshlrev_b32 v102, 16, v93
v_and_b32 v103, 0xffff0000, v93
v_add_f32 v96, v96, v100
v_add_f32 v97, v97, v101
v_add_f32 v98, v98, v102
v_add_f32 v99, v99, v103
v_lshlrev_b32 v100, 16, v94
v_and_b32 v101, 0xffff0000, v94
v_lshlrev_b32 v102, 16, v95
v_and_b32 v103, 0xffff0000, v95
v_add_f32 v96, v96, v100
v_add_f32 v97, v97, v101
v_add_f32 v98, v98, v102
v_add_f32 v99, v99, v103
v_cvt_pk_bf16_f32 v80, v96, v97
v_cvt_pk_bf16_f32 v81, v98, v99
s_mov_b32 exec_hi, 0
buffer_store_dwordx2 v[80:81], v105, s[16:19], s38 offen
s_mov_b32 exec_hi, -1
L_CDONE:
L_END:
s_endpgm
L_CODE_END:
.section .rodata,"a"
.p2align 6
.amdhsa_kernel standalone__dense_activation_silu__sampling_kernel
  .amdhsa_next_free_vgpr 132
  .amdhsa_next_free_sgpr 102
  .amdhsa_accum_offset 132
  .amdhsa_group_segment_fixed_size 0
  .amdhsa_kernarg_size 48
  .amdhsa_user_sgpr_count 2
  .amdhsa_user_sgpr_kernarg_segment_ptr 1
  .amdhsa_system_sgpr_workgroup_id_x 1
  .amdhsa_float_denorm_mode_32 3
.end_amdhsa_kernel
.text
```
